```python
import torch

def _softmax(x, axis=-1):
    return torch.softmax(x, dim=axis)
def _gelu(x):
    return torch.nn.functional.gelu(x, approximate="tanh")
def _silu(x):
    return torch.nn.functional.silu(x)
def _sigmoid(x):
    return torch.sigmoid(x)
def _layernorm(x, axis=-1, eps=1e-5):
    m = x.mean(dim=axis, keepdim=True)
    v = x.var(dim=axis, keepdim=True, unbiased=False)
    return (x - m) / torch.sqrt(v + eps)
def _scatter_add(tgt, idx, src, axis=0):
    return tgt.clone().index_add_(axis, idx, src)
def _segment_sum(src, seg, n):
    out = torch.zeros((n,) + src.shape[1:], dtype=src.dtype)
    return out.index_add_(0, seg, src)
def _pad(x, pw):
    flat = tuple(v for pair in reversed(pw) for v in pair)
    return torch.nn.functional.pad(x, flat)

kernel_name = 'parallel_sum__compressed_kv_cla__dense_activation_gelu__prompt'

def setup_inputs():

    _w = (lambda a: (lambda t: t.to(torch.bfloat16) if t.is_floating_point() else t)(torch.as_tensor(a)))
    def _A_setup():
        B, H, Sq, Sk, D, M = 1, 32, 2048, 2048, 128, 512
        Dc = 4 * D
        return {
            "x": _w((lambda *s: torch.randn(*s, dtype=torch.bfloat16) * 0.05)(B, Sq, M)),
            "c_kv": _w((lambda *s: torch.randn(*s, dtype=torch.bfloat16) * 0.4)(B, Sk, Dc)),
            "w_q": _w((lambda *s: torch.randn(*s, dtype=torch.bfloat16) * 3.2)(M, H, D) * (M ** -0.5)),
            "w_uk": _w((lambda *s: torch.randn(*s, dtype=torch.bfloat16) * 3.2)(Dc, H, D) * (Dc ** -0.5)),
            "w_uv": _w((lambda *s: torch.randn(*s, dtype=torch.bfloat16) * 0.4)(Dc, H, D) * (Dc ** -0.5)),
            "w_o": _w((lambda *s: torch.randn(*s, dtype=torch.bfloat16) * 0.4)(H, D, M) * ((H * D) ** -0.5)),
        }
    _A_in = _A_setup()

    def _B_setup():
        B, S, D, F = 1, 2048, 512, 1376
        return {
            "x": _w((lambda *s: torch.randn(*s, dtype=torch.bfloat16) * 0.05)(B, S, D)),
            "w1": _w((lambda *s: torch.randn(*s, dtype=torch.bfloat16) * 0.4)(D, F) * (D ** -0.5)),
            "b1": _w((lambda *s: torch.randn(*s, dtype=torch.bfloat16) * 12.8)(F) * 0.01),
            "w2": _w((lambda *s: torch.randn(*s, dtype=torch.bfloat16) * 0.2)(F, D) * (F ** -0.5)),
            "b2": _w((lambda *s: torch.randn(*s, dtype=torch.bfloat16) * 3.2)(D) * 0.01),
        }
    _B_in = _B_setup()

    return {
        "A_x": _A_in["x"],
        "A_c_kv": _A_in["c_kv"],
        "A_w_q": _A_in["w_q"],
        "A_w_uk": _A_in["w_uk"],
        "A_w_uv": _A_in["w_uv"],
        "A_w_o": _A_in["w_o"],
        "B_x": _B_in["x"],
        "B_w1": _B_in["w1"],
        "B_b1": _B_in["b1"],
        "B_w2": _B_in["w2"],
        "B_b2": _B_in["b2"],
    }

def reference(A_x, A_c_kv, A_w_q, A_w_uk, A_w_uv, A_w_o, B_x, B_w1, B_b1, B_w2, B_b2):
    def _A_ref(x, c_kv, w_q, w_uk, w_uv, w_o):
        B, Sq, M = x.shape[0], x.shape[1], x.shape[2]
        Sk = c_kv.shape[1]
        H, D = w_q.shape[1], w_q.shape[2]
        q = torch.einsum("bqm,mhd->bhqd", x, w_q)
        k = torch.einsum("bkc,chd->bhkd", c_kv, w_uk)
        v = torch.einsum("bkc,chd->bhkd", c_kv, w_uv)
        scores = torch.einsum("bhqd,bhkd->bhqk", q, k) * (D ** -0.5)
        off = Sk - Sq
        qi = torch.arange(Sq)[:, None]
        kj = torch.arange(Sk)[None, :]
        cmask = kj <= (qi + off)
        scores = torch.where(cmask[None, None], scores, -1e9)
        p = _softmax(scores, axis=-1)
        ctx = torch.einsum("bhqk,bhkd->bhqd", p, v)
        return torch.einsum("bhqd,hdm->bqm", ctx, w_o)

    def _B_ref(x, w1, b1, w2, b2):
        h = torch.einsum("bsd,df->bsf", x, w1) + b1
        h = _gelu(h)
        return torch.einsum("bsf,fd->bsd", h, w2) + b2

    x = A_x
    xn = _layernorm(x, axis=-1)
    return x + _A_ref(xn, A_c_kv, A_w_q, A_w_uk, A_w_uv, A_w_o) + _B_ref(xn, B_w1, B_b1, B_w2, B_b2)
```

```asm
; @launch kernel=ln_kernel grid=(256,1,1) block=(256,1,1) lds=0
; @launch kernel=proj_kernel grid=(256,1,1) block=(512,1,1) lds=132096
; @launch kernel=attn_kernel grid=(256,1,1) block=(512,1,1) lds=135168
; @launch kernel=outg_kernel grid=(256,1,1) block=(512,1,1) lds=131072
; @launch kernel=red_kernel grid=(1024,1,1) block=(256,1,1) lds=0
.amdgcn_target "amdgcn-amd-amdhsa--gfx950"
.text
.globl ln_kernel
.p2align 8
.type ln_kernel,@function
ln_kernel:
    s_cmp_ge_u32 s2, 256
    s_cbranch_scc1 ln_end
    s_load_dwordx2 s[4:5], s[0:1], 0
    s_load_dwordx2 s[8:9], s[0:1], 8
    s_load_dwordx2 s[6:7], s[0:1], 104
    v_and_b32 v1, 63, v0
    v_lshlrev_b32 v1, 4, v1
    v_lshrrev_b32 v2, 6, v0
    v_lshlrev_b32 v2, 11, v2
    v_add_u32 v1, v1, v2
    s_lshl_b32 s24, s2, 13
    s_waitcnt lgkmcnt(0)
    s_mov_b32 s12, s4
    s_mov_b32 s13, s5
    s_mov_b32 s14, 0x200000
    s_mov_b32 s15, 0x20000
    s_add_u32 s16, s6, 0x4560000
    s_addc_u32 s17, s7, 0
    s_mov_b32 s18, 0x400000
    s_mov_b32 s19, 0x20000
    s_mov_b32 s20, s8
    s_mov_b32 s21, s9
    s_mov_b32 s22, 0x200000
    s_mov_b32 s23, 0x20000
    v_and_b32 v4, 63, v0
    v_lshrrev_b32 v3, 1, v4
    v_lshlrev_b32 v3, 10, v3
    v_and_b32 v4, 1, v4
    v_lshlrev_b32 v4, 9, v4
    v_add_u32 v3, v3, v4
    v_lshrrev_b32 v4, 6, v0
    v_lshlrev_b32 v4, 5, v4
    v_add_u32 v3, v3, v4
    s_and_b32 s25, s2, 3
    s_lshl_b32 s25, s25, 7
    v_add_u32 v3, s25, v3
    s_lshr_b32 s25, s2, 2
    s_lshl_b32 s25, s25, 15
    s_add_u32 s26, s25, 0x200000
    buffer_load_dwordx4 v[8:11], v1, s[20:23], s24 offen
    buffer_load_dwordx4 v[12:15], v1, s[20:23], s24 offen offset:1024
    s_waitcnt vmcnt(1)
    buffer_store_dwordx4 v[8:11], v3, s[16:19], s26 offen
    s_waitcnt vmcnt(1)
    buffer_store_dwordx4 v[12:15], v3, s[16:19], s26 offen offset:16
    buffer_load_dwordx4 v[16:19], v1, s[12:15], s24 offen
    buffer_load_dwordx4 v[20:23], v1, s[12:15], s24 offen offset:1024
    s_waitcnt vmcnt(1)
    v_lshlrev_b32 v24, 16, v16
    v_and_b32 v25, 0xffff0000, v16
    v_lshlrev_b32 v26, 16, v17
    v_and_b32 v27, 0xffff0000, v17
    v_lshlrev_b32 v28, 16, v18
    v_and_b32 v29, 0xffff0000, v18
    v_lshlrev_b32 v30, 16, v19
    v_and_b32 v31, 0xffff0000, v19
    s_waitcnt vmcnt(0)
    v_lshlrev_b32 v32, 16, v20
    v_and_b32 v33, 0xffff0000, v20
    v_lshlrev_b32 v34, 16, v21
    v_and_b32 v35, 0xffff0000, v21
    v_lshlrev_b32 v36, 16, v22
    v_and_b32 v37, 0xffff0000, v22
    v_lshlrev_b32 v38, 16, v23
    v_and_b32 v39, 0xffff0000, v23
    v_add_f32 v42, v24, v25
    v_add_f32 v40, v26, v27
    v_add_f32 v42, v42, v40
    v_add_f32 v40, v28, v29
    v_add_f32 v42, v42, v40
    v_add_f32 v40, v30, v31
    v_add_f32 v40, v42, v40
    v_add_f32 v43, v32, v33
    v_add_f32 v41, v34, v35
    v_add_f32 v43, v43, v41
    v_add_f32 v41, v36, v37
    v_add_f32 v43, v43, v41
    v_add_f32 v41, v38, v39
    v_add_f32 v41, v43, v41
    ds_swizzle_b32 v42, v40 offset:0x41f
    ds_swizzle_b32 v43, v41 offset:0x41f
    s_waitcnt lgkmcnt(1)
    v_add_f32 v40, v40, v42
    s_waitcnt lgkmcnt(0)
    v_add_f32 v41, v41, v43
    ds_swizzle_b32 v42, v40 offset:0x81f
    ds_swizzle_b32 v43, v41 offset:0x81f
    s_waitcnt lgkmcnt(1)
    v_add_f32 v40, v40, v42
    s_waitcnt lgkmcnt(0)
    v_add_f32 v41, v41, v43
    ds_swizzle_b32 v42, v40 offset:0x101f
    ds_swizzle_b32 v43, v41 offset:0x101f
    s_waitcnt lgkmcnt(1)
    v_add_f32 v40, v40, v42
    s_waitcnt lgkmcnt(0)
    v_add_f32 v41, v41, v43
    ds_swizzle_b32 v42, v40 offset:0x201f
    ds_swizzle_b32 v43, v41 offset:0x201f
    s_waitcnt lgkmcnt(1)
    v_add_f32 v40, v40, v42
    s_waitcnt lgkmcnt(0)
    v_add_f32 v41, v41, v43
    ds_swizzle_b32 v42, v40 offset:0x401f
    ds_swizzle_b32 v43, v41 offset:0x401f
    s_waitcnt lgkmcnt(1)
    v_add_f32 v40, v40, v42
    s_waitcnt lgkmcnt(0)
    v_add_f32 v41, v41, v43
    v_mov_b32 v42, v40
    v_mov_b32 v43, v41
    s_nop 0
    v_permlane32_swap_b32 v40, v42
    v_permlane32_swap_b32 v41, v43
    v_add_f32 v40, v40, v42
    v_add_f32 v41, v41, v43
    v_mul_f32 v44, 0x3b000000, v40
    v_mul_f32 v45, 0x3b000000, v41
    v_sub_f32 v48, v24, v44
    v_sub_f32 v49, v25, v44
    v_sub_f32 v50, v26, v44
    v_sub_f32 v51, v27, v44
    v_sub_f32 v52, v28, v44
    v_sub_f32 v53, v29, v44
    v_sub_f32 v54, v30, v44
    v_sub_f32 v55, v31, v44
    v_mul_f32 v40, v48, v48
    v_fmac_f32 v40, v49, v49
    v_fmac_f32 v40, v50, v50
    v_fmac_f32 v40, v51, v51
    v_fmac_f32 v40, v52, v52
    v_fmac_f32 v40, v53, v53
    v_fmac_f32 v40, v54, v54
    v_fmac_f32 v40, v55, v55
    v_sub_f32 v56, v32, v45
    v_sub_f32 v57, v33, v45
    v_sub_f32 v58, v34, v45
    v_sub_f32 v59, v35, v45
    v_sub_f32 v60, v36, v45
    v_sub_f32 v61, v37, v45
    v_sub_f32 v62, v38, v45
    v_sub_f32 v63, v39, v45
    v_mul_f32 v41, v56, v56
    v_fmac_f32 v41, v57, v57
    v_fmac_f32 v41, v58, v58
    v_fmac_f32 v41, v59, v59
    v_fmac_f32 v41, v60, v60
    v_fmac_f32 v41, v61, v61
    v_fmac_f32 v41, v62, v62
    v_fmac_f32 v41, v63, v63
    ds_swizzle_b32 v42, v40 offset:0x41f
    ds_swizzle_b32 v43, v41 offset:0x41f
    s_waitcnt lgkmcnt(1)
    v_add_f32 v40, v40, v42
    s_waitcnt lgkmcnt(0)
    v_add_f32 v41, v41, v43
    ds_swizzle_b32 v42, v40 offset:0x81f
    ds_swizzle_b32 v43, v41 offset:0x81f
    s_waitcnt lgkmcnt(1)
    v_add_f32 v40, v40, v42
    s_waitcnt lgkmcnt(0)
    v_add_f32 v41, v41, v43
    ds_swizzle_b32 v42, v40 offset:0x101f
    ds_swizzle_b32 v43, v41 offset:0x101f
    s_waitcnt lgkmcnt(1)
    v_add_f32 v40, v40, v42
    s_waitcnt lgkmcnt(0)
    v_add_f32 v41, v41, v43
    ds_swizzle_b32 v42, v40 offset:0x201f
    ds_swizzle_b32 v43, v41 offset:0x201f
    s_waitcnt lgkmcnt(1)
    v_add_f32 v40, v40, v42
    s_waitcnt lgkmcnt(0)
    v_add_f32 v41, v41, v43
    ds_swizzle_b32 v42, v40 offset:0x401f
    ds_swizzle_b32 v43, v41 offset:0x401f
    s_waitcnt lgkmcnt(1)
    v_add_f32 v40, v40, v42
    s_waitcnt lgkmcnt(0)
    v_add_f32 v41, v41, v43
    v_mov_b32 v42, v40
    v_mov_b32 v43, v41
    s_nop 0
    v_permlane32_swap_b32 v40, v42
    v_permlane32_swap_b32 v41, v43
    v_add_f32 v40, v40, v42
    v_add_f32 v41, v41, v43
    v_mul_f32 v40, 0x3b000000, v40
    v_cvt_pk_bf16_f32 v40, v40, v40
    v_lshlrev_b32 v40, 16, v40
    v_add_f32 v40, 0x3727c5ac, v40
    v_cvt_pk_bf16_f32 v40, v40, v40
    v_lshlrev_b32 v40, 16, v40
    v_sqrt_f32 v40, v40
    s_nop 0
    v_cvt_pk_bf16_f32 v40, v40, v40
    v_lshlrev_b32 v40, 16, v40
    v_rcp_f32 v64, v40
    v_cvt_pk_bf16_f32 v44, v44, v44
    v_lshlrev_b32 v44, 16, v44
    v_mul_f32 v41, 0x3b000000, v41
    v_cvt_pk_bf16_f32 v41, v41, v41
    v_lshlrev_b32 v41, 16, v41
    v_add_f32 v41, 0x3727c5ac, v41
    v_cvt_pk_bf16_f32 v41, v41, v41
    v_lshlrev_b32 v41, 16, v41
    v_sqrt_f32 v41, v41
    s_nop 0
    v_cvt_pk_bf16_f32 v41, v41, v41
    v_lshlrev_b32 v41, 16, v41
    v_rcp_f32 v65, v41
    v_cvt_pk_bf16_f32 v45, v45, v45
    v_lshlrev_b32 v45, 16, v45
    v_sub_f32 v24, v24, v44
    v_sub_f32 v25, v25, v44
    v_cvt_pk_bf16_f32 v16, v24, v25
    v_sub_f32 v26, v26, v44
    v_sub_f32 v27, v27, v44
    v_cvt_pk_bf16_f32 v17, v26, v27
    v_sub_f32 v28, v28, v44
    v_sub_f32 v29, v29, v44
    v_cvt_pk_bf16_f32 v18, v28, v29
    v_sub_f32 v30, v30, v44
    v_sub_f32 v31, v31, v44
    v_cvt_pk_bf16_f32 v19, v30, v31
    v_lshlrev_b32 v24, 16, v16
    v_and_b32 v25, 0xffff0000, v16
    v_lshlrev_b32 v26, 16, v17
    v_and_b32 v27, 0xffff0000, v17
    v_lshlrev_b32 v28, 16, v18
    v_and_b32 v29, 0xffff0000, v18
    v_lshlrev_b32 v30, 16, v19
    v_and_b32 v31, 0xffff0000, v19
    v_mul_f32 v24, v24, v64
    v_mul_f32 v25, v25, v64
    v_mul_f32 v26, v26, v64
    v_mul_f32 v27, v27, v64
    v_mul_f32 v28, v28, v64
    v_mul_f32 v29, v29, v64
    v_mul_f32 v30, v30, v64
    v_mul_f32 v31, v31, v64
    v_cvt_pk_bf16_f32 v16, v24, v25
    v_cvt_pk_bf16_f32 v17, v26, v27
    v_cvt_pk_bf16_f32 v18, v28, v29
    v_cvt_pk_bf16_f32 v19, v30, v31
    buffer_store_dwordx4 v[16:19], v3, s[16:19], s25 offen
    v_sub_f32 v32, v32, v45
    v_sub_f32 v33, v33, v45
    v_cvt_pk_bf16_f32 v20, v32, v33
    v_sub_f32 v34, v34, v45
    v_sub_f32 v35, v35, v45
    v_cvt_pk_bf16_f32 v21, v34, v35
    v_sub_f32 v36, v36, v45
    v_sub_f32 v37, v37, v45
    v_cvt_pk_bf16_f32 v22, v36, v37
    v_sub_f32 v38, v38, v45
    v_sub_f32 v39, v39, v45
    v_cvt_pk_bf16_f32 v23, v38, v39
    v_lshlrev_b32 v32, 16, v20
    v_and_b32 v33, 0xffff0000, v20
    v_lshlrev_b32 v34, 16, v21
    v_and_b32 v35, 0xffff0000, v21
    v_lshlrev_b32 v36, 16, v22
    v_and_b32 v37, 0xffff0000, v22
    v_lshlrev_b32 v38, 16, v23
    v_and_b32 v39, 0xffff0000, v23
    v_mul_f32 v32, v32, v65
    v_mul_f32 v33, v33, v65
    v_mul_f32 v34, v34, v65
    v_mul_f32 v35, v35, v65
    v_mul_f32 v36, v36, v65
    v_mul_f32 v37, v37, v65
    v_mul_f32 v38, v38, v65
    v_mul_f32 v39, v39, v65
    v_cvt_pk_bf16_f32 v20, v32, v33
    v_cvt_pk_bf16_f32 v21, v34, v35
    v_cvt_pk_bf16_f32 v22, v36, v37
    v_cvt_pk_bf16_f32 v23, v38, v39
    buffer_store_dwordx4 v[20:23], v3, s[16:19], s25 offen offset:16
ln_end:
    s_endpgm
.section .rodata,"a"
.p2align 6
.amdhsa_kernel ln_kernel
  .amdhsa_next_free_vgpr 72
  .amdhsa_next_free_sgpr 27
  .amdhsa_accum_offset 72
  .amdhsa_group_segment_fixed_size 0
  .amdhsa_kernarg_size 112
  .amdhsa_user_sgpr_count 2
  .amdhsa_user_sgpr_kernarg_segment_ptr 1
  .amdhsa_system_sgpr_workgroup_id_x 1
.end_amdhsa_kernel

.text
.globl proj_kernel
.p2align 8
.type proj_kernel,@function
proj_kernel:
    s_cmp_ge_u32 s2, 256
    s_cbranch_scc1 proj_end
    s_load_dwordx8 s[4:11], s[0:1], 8
    s_load_dwordx4 s[12:15], s[0:1], 56
    s_load_dwordx2 s[16:17], s[0:1], 104
    v_lshrrev_b32 v1, 6, v0
    v_and_b32 v2, 63, v0
    v_readfirstlane_b32 s18, v1
    v_lshrrev_b32 v3, 5, v2
    v_and_b32 v4, 31, v2
    s_lshr_b32 s21, s2, 3
    s_and_b32 s19, s21, 7
    s_lshr_b32 s21, s21, 3
    s_lshl_b32 s21, s21, 3
    s_and_b32 s20, s2, 7
    s_add_u32 s20, s20, s21
    s_mov_b32 s23, 0
    s_mov_b32 s24, s20
    s_cmp_ge_u32 s20, 9
    s_cselect_b32 s21, 1, 0
    s_add_u32 s23, s23, s21
    s_cmp_ge_u32 s20, 18
    s_cselect_b32 s21, 1, 0
    s_add_u32 s23, s23, s21
    s_cmp_ge_u32 s20, 27
    s_cselect_b32 s21, 1, 0
    s_add_u32 s23, s23, s21
    s_mul_i32 s21, s23, 9
    s_sub_u32 s24, s20, s21
    s_mul_i32 s25, s24, 14
    s_min_u32 s21, s24, 2
    s_add_u32 s25, s25, s21
    s_cmp_lt_u32 s24, 2
    s_cselect_b32 s26, 15, 14
    s_mul_i32 s21, s24, 9
    s_sub_u32 s22, s24, 3
    s_cmp_ge_u32 s24, 3
    s_cselect_b32 s22, s22, 0
    s_sub_u32 s21, s21, s22
    s_cmp_ge_u32 s24, 3
    s_cselect_b32 s22, 8, 9
    s_cmp_eq_u32 s23, 3
    s_cselect_b32 s25, s21, s25
    s_cselect_b32 s26, s22, s26
    s_waitcnt lgkmcnt(0)
    s_cmp_eq_u32 s23, 0
    s_cselect_b32 s21, 1, 0
    s_cmp_eq_u32 s23, 3
    s_cselect_b32 s22, 1, 0
    s_or_b32 s21, s21, s22
    s_mov_b32 s44, 0x4560000
    s_cmp_eq_u32 s21, 1
    s_cselect_b32 s44, s44, 0x4760000
    s_cmp_eq_u32 s23, 0
    s_cselect_b32 s32, s6, s8
    s_cselect_b32 s33, s7, s9
    s_cmp_eq_u32 s23, 2
    s_cselect_b32 s32, s10, s32
    s_cselect_b32 s33, s11, s33
    s_cmp_eq_u32 s23, 3
    s_cselect_b32 s32, s12, s32
    s_cselect_b32 s33, s13, s33
    s_mov_b32 s21, 0x158000
    s_cselect_b32 s34, s21, 0x400000
    s_mov_b32 s35, 0x20000
    s_mov_b32 s36, s16
    s_mov_b32 s37, s17
    s_mov_b32 s38, 0x10000000
    s_mov_b32 s39, 0x20000
    s_mov_b32 s40, s14
    s_mov_b32 s41, s15
    s_mov_b32 s42, 0xac0
    s_mov_b32 s43, 0x20000
    v_lshlrev_b32 v5, 4, v2
    v_and_b32 v6, 15, v2
    v_lshrrev_b32 v6, 2, v6
    v_lshlrev_b32 v8, 3, v3
    v_add_u32 v6, v6, v8
    v_lshlrev_b32 v7, 6, v6
    v_lshrrev_b32 v6, 4, v2
    v_and_b32 v6, 1, v6
    v_lshlrev_b32 v6, 5, v6
    v_add_u32 v7, v7, v6
    v_and_b32 v6, 3, v2
    v_lshlrev_b32 v6, 3, v6
    v_add_u32 v7, v7, v6
    s_mov_b32 s63, 0x40000000
    s_lshl_b32 s59, s18, 12
    s_cmp_eq_u32 s23, 2
    s_cbranch_scc1 proj_type_v
    s_cmp_eq_u32 s23, 3
    s_cbranch_scc1 proj_type_f
    v_lshrrev_b32 v6, 2, v2
    s_mov_b32 s21, 8192
    v_mul_lo_u32 v214, v6, s21
    v_and_b32 v6, 3, v2
    v_lshlrev_b32 v6, 4, v6
    v_add_u32 v214, v214, v6
    s_lshl_b32 s21, s19, 3
    s_add_u32 s21, s21, s18
    s_mul_i32 s21, s21, 8192
    v_lshlrev_b32 v215, 4, v2
    v_add_u32 v215, s21, v215
    s_mul_i32 s45, s18, 524288
    s_lshl_b32 s21, s25, 6
    s_add_u32 s45, s45, s21
    s_mov_b32 s46, s26
    s_mov_b32 s47, 0
    s_mov_b32 s48, 0
    s_mov_b32 s50, s25
    s_cmp_eq_u32 s23, 0
    s_cselect_b32 s51, 0, 0x1000000
    s_cmp_gt_i32 s46, 0
    s_cselect_b32 s57, s45, s63
    s_sub_u32 s46, s46, 1
    s_add_u32 s58, s47, s59
    s_mov_b32 m0, s58
    s_add_u32 s53, s57, 130048
    s_add_u32 s54, s57, 260096
    s_add_u32 s55, s57, 390144
    s_add_u32 s45, s45, 64
    s_add_u32 s47, s47, 32768
    s_and_b32 s47, s47, 131071
    buffer_load_dwordx4 v214, s[32:35], s57 offen lds
    buffer_load_dwordx4 v214, s[32:35], s53 offen offset:1024 lds
    buffer_load_dwordx4 v214, s[32:35], s54 offen offset:2048 lds
    buffer_load_dwordx4 v214, s[32:35], s55 offen offset:3072 lds
    s_cmp_gt_i32 s46, 0
    s_cselect_b32 s57, s45, s63
    s_sub_u32 s46, s46, 1
    s_add_u32 s58, s47, s59
    s_mov_b32 m0, s58
    s_add_u32 s53, s57, 130048
    s_add_u32 s54, s57, 260096
    s_add_u32 s55, s57, 390144
    s_add_u32 s45, s45, 64
    s_add_u32 s47, s47, 32768
    s_and_b32 s47, s47, 131071
    buffer_load_dwordx4 v214, s[32:35], s57 offen lds
    buffer_load_dwordx4 v214, s[32:35], s53 offen offset:1024 lds
    buffer_load_dwordx4 v214, s[32:35], s54 offen offset:2048 lds
    buffer_load_dwordx4 v214, s[32:35], s55 offen offset:3072 lds
    s_cmp_gt_i32 s46, 0
    s_cselect_b32 s57, s45, s63
    s_sub_u32 s46, s46, 1
    s_add_u32 s58, s47, s59
    s_mov_b32 m0, s58
    s_add_u32 s53, s57, 130048
    s_add_u32 s54, s57, 260096
    s_add_u32 s55, s57, 390144
    s_add_u32 s45, s45, 64
    s_add_u32 s47, s47, 32768
    s_and_b32 s47, s47, 131071
    buffer_load_dwordx4 v214, s[32:35], s57 offen lds
    buffer_load_dwordx4 v214, s[32:35], s53 offen offset:1024 lds
    buffer_load_dwordx4 v214, s[32:35], s54 offen offset:2048 lds
    buffer_load_dwordx4 v214, s[32:35], s55 offen offset:3072 lds
    s_lshl_b32 s21, s19, 3
    s_add_u32 s21, s21, s18
    s_lshl_b32 s21, s21, 15
    s_add_u32 s21, s21, s44
    s_mov_b32 s56, s21
    buffer_load_dwordx4 v[12:15], v5, s[36:39], s56 offen
    buffer_load_dwordx4 v[16:19], v5, s[36:39], s56 offen offset:1024
    buffer_load_dwordx4 v[20:23], v5, s[36:39], s56 offen offset:2048
    buffer_load_dwordx4 v[24:27], v5, s[36:39], s56 offen offset:3072
    s_add_u32 s56, s56, 4096
    buffer_load_dwordx4 v[28:31], v5, s[36:39], s56 offen
    buffer_load_dwordx4 v[32:35], v5, s[36:39], s56 offen offset:1024
    buffer_load_dwordx4 v[36:39], v5, s[36:39], s56 offen offset:2048
    buffer_load_dwordx4 v[40:43], v5, s[36:39], s56 offen offset:3072
    s_waitcnt vmcnt(8)
    s_barrier
    v_mov_b32 v212, v7
    v_add_u32 v213, 32768, v7
    s_mov_b32 s48, 32768
    ds_read_b64_tr_b16 v[172:173], v212
    ds_read_b64_tr_b16 v[174:175], v212 offset:256
    ds_read_b64_tr_b16 v[176:177], v212 offset:1024
    ds_read_b64_tr_b16 v[178:179], v212 offset:1280
    ds_read_b64_tr_b16 v[180:181], v212 offset:2048
    ds_read_b64_tr_b16 v[182:183], v212 offset:2304
    ds_read_b64_tr_b16 v[184:185], v212 offset:3072
    ds_read_b64_tr_b16 v[186:187], v212 offset:3328
    ds_read_b64_tr_b16 v[188:189], v212 offset:4096
    ds_read_b64_tr_b16 v[190:191], v212 offset:4352
    ds_read_b64_tr_b16 v[192:193], v212 offset:5120
    ds_read_b64_tr_b16 v[194:195], v212 offset:5376
    ds_read_b64_tr_b16 v[196:197], v212 offset:6144
    ds_read_b64_tr_b16 v[198:199], v212 offset:6400
    s_cmp_gt_i32 s46, 0
    s_cselect_b32 s57, s45, s63
    s_sub_u32 s46, s46, 1
    s_add_u32 s58, s47, s59
    s_mov_b32 m0, s58
    s_add_u32 s53, s57, 130048
    s_add_u32 s54, s57, 260096
    s_add_u32 s55, s57, 390144
    s_add_u32 s45, s45, 64
    s_add_u32 s47, s47, 32768
    s_and_b32 s47, s47, 131071
    ds_read_b64_tr_b16 v[200:201], v212 offset:7168
    ds_read_b64_tr_b16 v[202:203], v212 offset:7424
    s_waitcnt lgkmcnt(14)
    s_add_u32 s56, s56, 4096
    buffer_load_dwordx4 v[44:47], v5, s[36:39], s56 offen
    s_waitcnt vmcnt(8)
    v_mfma_f32_32x32x16_bf16 v[140:155], v[172:175], v[12:15], 0
    buffer_load_dwordx4 v214, s[32:35], s57 offen lds
    ds_read_b64_tr_b16 v[172:173], v212 offset:8192
    ds_read_b64_tr_b16 v[174:175], v212 offset:8448
    s_waitcnt lgkmcnt(14)
    buffer_load_dwordx4 v[48:51], v5, s[36:39], s56 offen offset:1024
    s_waitcnt vmcnt(9)
    v_mfma_f32_32x32x16_bf16 v[140:155], v[176:179], v[16:19], v[140:155]
    buffer_load_dwordx4 v214, s[32:35], s53 offen offset:1024 lds
    ds_read_b64_tr_b16 v[176:177], v212 offset:9216
    ds_read_b64_tr_b16 v[178:179], v212 offset:9472
    s_waitcnt lgkmcnt(14)
    buffer_load_dwordx4 v[52:55], v5, s[36:39], s56 offen offset:2048
    s_waitcnt vmcnt(10)
    v_mfma_f32_32x32x16_bf16 v[140:155], v[180:183], v[20:23], v[140:155]
    buffer_load_dwordx4 v214, s[32:35], s54 offen offset:2048 lds
    ds_read_b64_tr_b16 v[180:181], v212 offset:10240
    ds_read_b64_tr_b16 v[182:183], v212 offset:10496
    s_waitcnt lgkmcnt(14)
    buffer_load_dwordx4 v[56:59], v5, s[36:39], s56 offen offset:3072
    s_waitcnt vmcnt(11)
    v_mfma_f32_32x32x16_bf16 v[140:155], v[184:187], v[24:27], v[140:155]
    buffer_load_dwordx4 v214, s[32:35], s55 offen offset:3072 lds
    ds_read_b64_tr_b16 v[184:185], v212 offset:11264
    ds_read_b64_tr_b16 v[186:187], v212 offset:11520
    s_waitcnt lgkmcnt(14)
    s_add_u32 s56, s56, 4096
    buffer_load_dwordx4 v[60:63], v5, s[36:39], s56 offen
    s_waitcnt vmcnt(12)
    v_mfma_f32_32x32x16_bf16 v[140:155], v[188:191], v[28:31], v[140:155]
    ds_read_b64_tr_b16 v[188:189], v212 offset:12288
    ds_read_b64_tr_b16 v[190:191], v212 offset:12544
    s_waitcnt lgkmcnt(14)
    buffer_load_dwordx4 v[64:67], v5, s[36:39], s56 offen offset:1024
    s_waitcnt vmcnt(12)
    v_mfma_f32_32x32x16_bf16 v[140:155], v[192:195], v[32:35], v[140:155]
    ds_read_b64_tr_b16 v[192:193], v212 offset:13312
    ds_read_b64_tr_b16 v[194:195], v212 offset:13568
    s_waitcnt lgkmcnt(14)
    buffer_load_dwordx4 v[68:71], v5, s[36:39], s56 offen offset:2048
    s_waitcnt vmcnt(12)
    v_mfma_f32_32x32x16_bf16 v[140:155], v[196:199], v[36:39], v[140:155]
    ds_read_b64_tr_b16 v[196:197], v212 offset:14336
    ds_read_b64_tr_b16 v[198:199], v212 offset:14592
    s_waitcnt lgkmcnt(14)
    buffer_load_dwordx4 v[72:75], v5, s[36:39], s56 offen offset:3072
    s_waitcnt vmcnt(12)
    v_mfma_f32_32x32x16_bf16 v[140:155], v[200:203], v[40:43], v[140:155]
    ds_read_b64_tr_b16 v[200:201], v212 offset:15360
    ds_read_b64_tr_b16 v[202:203], v212 offset:15616
    s_waitcnt lgkmcnt(14)
    s_add_u32 s56, s56, 4096
    buffer_load_dwordx4 v[76:79], v5, s[36:39], s56 offen
    s_waitcnt vmcnt(12)
    v_mfma_f32_32x32x16_bf16 v[140:155], v[172:175], v[44:47], v[140:155]
    ds_read_b64_tr_b16 v[172:173], v212 offset:16384
    ds_read_b64_tr_b16 v[174:175], v212 offset:16640
    s_waitcnt lgkmcnt(14)
    buffer_load_dwordx4 v[80:83], v5, s[36:39], s56 offen offset:1024
    s_waitcnt vmcnt(11)
    v_mfma_f32_32x32x16_bf16 v[140:155], v[176:179], v[48:51], v[140:155]
    ds_read_b64_tr_b16 v[176:177], v212 offset:17408
    ds_read_b64_tr_b16 v[178:179], v212 offset:17664
    s_waitcnt lgkmcnt(14)
    buffer_load_dwordx4 v[84:87], v5, s[36:39], s56 offen offset:2048
    s_waitcnt vmcnt(10)
    v_mfma_f32_32x32x16_bf16 v[140:155], v[180:183], v[52:55], v[140:155]
    ds_read_b64_tr_b16 v[180:181], v212 offset:18432
    ds_read_b64_tr_b16 v[182:183], v212 offset:18688
    s_waitcnt lgkmcnt(14)
    buffer_load_dwordx4 v[88:91], v5, s[36:39], s56 offen offset:3072
    s_waitcnt vmcnt(9)
    v_mfma_f32_32x32x16_bf16 v[140:155], v[184:187], v[56:59], v[140:155]
    ds_read_b64_tr_b16 v[184:185], v212 offset:19456
    ds_read_b64_tr_b16 v[186:187], v212 offset:19712
    s_waitcnt lgkmcnt(14)
    s_add_u32 s56, s56, 4096
    buffer_load_dwordx4 v[92:95], v5, s[36:39], s56 offen
    s_waitcnt vmcnt(8)
    v_mfma_f32_32x32x16_bf16 v[140:155], v[188:191], v[60:63], v[140:155]
    ds_read_b64_tr_b16 v[188:189], v212 offset:20480
    ds_read_b64_tr_b16 v[190:191], v212 offset:20736
    s_waitcnt lgkmcnt(14)
    buffer_load_dwordx4 v[96:99], v5, s[36:39], s56 offen offset:1024
    s_waitcnt vmcnt(8)
    v_mfma_f32_32x32x16_bf16 v[140:155], v[192:195], v[64:67], v[140:155]
    ds_read_b64_tr_b16 v[192:193], v212 offset:21504
    ds_read_b64_tr_b16 v[194:195], v212 offset:21760
    s_waitcnt lgkmcnt(14)
    buffer_load_dwordx4 v[100:103], v5, s[36:39], s56 offen offset:2048
    s_waitcnt vmcnt(8)
    v_mfma_f32_32x32x16_bf16 v[140:155], v[196:199], v[68:71], v[140:155]
    ds_read_b64_tr_b16 v[196:197], v212 offset:22528
    ds_read_b64_tr_b16 v[198:199], v212 offset:22784
    s_waitcnt lgkmcnt(14)
    buffer_load_dwordx4 v[104:107], v5, s[36:39], s56 offen offset:3072
    s_waitcnt vmcnt(8)
    v_mfma_f32_32x32x16_bf16 v[140:155], v[200:203], v[72:75], v[140:155]
    ds_read_b64_tr_b16 v[200:201], v212 offset:23552
    ds_read_b64_tr_b16 v[202:203], v212 offset:23808
    s_waitcnt lgkmcnt(14)
    s_add_u32 s56, s56, 4096
    buffer_load_dwordx4 v[108:111], v5, s[36:39], s56 offen
    s_waitcnt vmcnt(8)
    v_mfma_f32_32x32x16_bf16 v[140:155], v[172:175], v[76:79], v[140:155]
    ds_read_b64_tr_b16 v[172:173], v212 offset:24576
    ds_read_b64_tr_b16 v[174:175], v212 offset:24832
    s_waitcnt lgkmcnt(14)
    buffer_load_dwordx4 v[112:115], v5, s[36:39], s56 offen offset:1024
    s_waitcnt vmcnt(8)
    v_mfma_f32_32x32x16_bf16 v[140:155], v[176:179], v[80:83], v[140:155]
    ds_read_b64_tr_b16 v[176:177], v212 offset:25600
    ds_read_b64_tr_b16 v[178:179], v212 offset:25856
    s_waitcnt lgkmcnt(14)
    buffer_load_dwordx4 v[116:119], v5, s[36:39], s56 offen offset:2048
    s_waitcnt vmcnt(8)
    v_mfma_f32_32x32x16_bf16 v[140:155], v[180:183], v[84:87], v[140:155]
    ds_read_b64_tr_b16 v[180:181], v212 offset:26624
    ds_read_b64_tr_b16 v[182:183], v212 offset:26880
    s_waitcnt lgkmcnt(14)
    buffer_load_dwordx4 v[120:123], v5, s[36:39], s56 offen offset:3072
    s_waitcnt vmcnt(8)
    v_mfma_f32_32x32x16_bf16 v[140:155], v[184:187], v[88:91], v[140:155]
    ds_read_b64_tr_b16 v[184:185], v212 offset:27648
    ds_read_b64_tr_b16 v[186:187], v212 offset:27904
    s_waitcnt lgkmcnt(14)
    s_add_u32 s56, s56, 4096
    buffer_load_dwordx4 v[124:127], v5, s[36:39], s56 offen
    s_waitcnt vmcnt(8)
    v_mfma_f32_32x32x16_bf16 v[140:155], v[188:191], v[92:95], v[140:155]
    ds_read_b64_tr_b16 v[188:189], v212 offset:28672
    ds_read_b64_tr_b16 v[190:191], v212 offset:28928
    s_waitcnt lgkmcnt(14)
    buffer_load_dwordx4 v[128:131], v5, s[36:39], s56 offen offset:1024
    s_waitcnt vmcnt(8)
    v_mfma_f32_32x32x16_bf16 v[140:155], v[192:195], v[96:99], v[140:155]
    ds_read_b64_tr_b16 v[192:193], v212 offset:29696
    ds_read_b64_tr_b16 v[194:195], v212 offset:29952
    s_waitcnt lgkmcnt(14)
    buffer_load_dwordx4 v[132:135], v5, s[36:39], s56 offen offset:2048
    s_waitcnt vmcnt(8)
    v_mfma_f32_32x32x16_bf16 v[140:155], v[196:199], v[100:103], v[140:155]
    ds_read_b64_tr_b16 v[196:197], v212 offset:30720
    ds_read_b64_tr_b16 v[198:199], v212 offset:30976
    s_waitcnt lgkmcnt(14)
    buffer_load_dwordx4 v[136:139], v5, s[36:39], s56 offen offset:3072
    s_waitcnt vmcnt(8)
    v_mfma_f32_32x32x16_bf16 v[140:155], v[200:203], v[104:107], v[140:155]
    ds_read_b64_tr_b16 v[200:201], v212 offset:31744
    ds_read_b64_tr_b16 v[202:203], v212 offset:32000
    s_waitcnt lgkmcnt(14)
    s_waitcnt vmcnt(7)
    v_mfma_f32_32x32x16_bf16 v[140:155], v[172:175], v[108:111], v[140:155]
    ds_read_b64_tr_b16 v[172:173], v213
    ds_read_b64_tr_b16 v[174:175], v213 offset:256
    s_waitcnt lgkmcnt(14)
    s_waitcnt vmcnt(6)
    v_mfma_f32_32x32x16_bf16 v[140:155], v[176:179], v[112:115], v[140:155]
    ds_read_b64_tr_b16 v[176:177], v213 offset:1024
    ds_read_b64_tr_b16 v[178:179], v213 offset:1280
    s_waitcnt lgkmcnt(14)
    s_waitcnt vmcnt(5)
    v_mfma_f32_32x32x16_bf16 v[140:155], v[180:183], v[116:119], v[140:155]
    ds_read_b64_tr_b16 v[180:181], v213 offset:2048
    ds_read_b64_tr_b16 v[182:183], v213 offset:2304
    s_waitcnt lgkmcnt(14)
    s_waitcnt vmcnt(4)
    v_mfma_f32_32x32x16_bf16 v[140:155], v[184:187], v[120:123], v[140:155]
    ds_read_b64_tr_b16 v[184:185], v213 offset:3072
    ds_read_b64_tr_b16 v[186:187], v213 offset:3328
    s_waitcnt lgkmcnt(14)
    s_waitcnt vmcnt(3)
    v_mfma_f32_32x32x16_bf16 v[140:155], v[188:191], v[124:127], v[140:155]
    ds_read_b64_tr_b16 v[188:189], v213 offset:4096
    ds_read_b64_tr_b16 v[190:191], v213 offset:4352
    s_waitcnt lgkmcnt(14)
    s_waitcnt vmcnt(2)
    v_mfma_f32_32x32x16_bf16 v[140:155], v[192:195], v[128:131], v[140:155]
    ds_read_b64_tr_b16 v[192:193], v213 offset:5120
    ds_read_b64_tr_b16 v[194:195], v213 offset:5376
    s_waitcnt lgkmcnt(14)
    s_waitcnt vmcnt(1)
    v_mfma_f32_32x32x16_bf16 v[140:155], v[196:199], v[132:135], v[140:155]
    ds_read_b64_tr_b16 v[196:197], v213 offset:6144
    ds_read_b64_tr_b16 v[198:199], v213 offset:6400
    s_waitcnt lgkmcnt(14)
    s_waitcnt vmcnt(0)
    v_mfma_f32_32x32x16_bf16 v[140:155], v[200:203], v[136:139], v[140:155]
    s_add_u32 s48, s48, 32768
    s_and_b32 s48, s48, 131071
    v_add_u32 v212, s48, v7
    s_sub_u32 s49, s26, 1
proj_qk_loop:
    s_waitcnt vmcnt(6)
    s_barrier
    s_cmp_gt_i32 s46, 0
    s_cselect_b32 s57, s45, s63
    s_sub_u32 s46, s46, 1
    s_add_u32 s58, s47, s59
    s_mov_b32 m0, s58
    s_add_u32 s53, s57, 130048
    s_add_u32 s54, s57, 260096
    s_add_u32 s55, s57, 390144
    s_add_u32 s45, s45, 64
    s_add_u32 s47, s47, 32768
    s_and_b32 s47, s47, 131071
    ds_read_b64_tr_b16 v[200:201], v213 offset:7168
    ds_read_b64_tr_b16 v[202:203], v213 offset:7424
    s_waitcnt lgkmcnt(14)
    v_mfma_f32_32x32x16_bf16 v[156:171], v[172:175], v[12:15], 0
    buffer_load_dwordx4 v214, s[32:35], s57 offen lds
    ds_read_b64_tr_b16 v[172:173], v213 offset:8192
    ds_read_b64_tr_b16 v[174:175], v213 offset:8448
    s_waitcnt lgkmcnt(14)
    v_mfma_f32_32x32x16_bf16 v[156:171], v[176:179], v[16:19], v[156:171]
    buffer_load_dwordx4 v214, s[32:35], s53 offen offset:1024 lds
    ds_read_b64_tr_b16 v[176:177], v213 offset:9216
    ds_read_b64_tr_b16 v[178:179], v213 offset:9472
    s_waitcnt lgkmcnt(14)
    v_mfma_f32_32x32x16_bf16 v[156:171], v[180:183], v[20:23], v[156:171]
    buffer_load_dwordx4 v214, s[32:35], s54 offen offset:2048 lds
    ds_read_b64_tr_b16 v[180:181], v213 offset:10240
    ds_read_b64_tr_b16 v[182:183], v213 offset:10496
    s_waitcnt lgkmcnt(14)
    v_mfma_f32_32x32x16_bf16 v[156:171], v[184:187], v[24:27], v[156:171]
    buffer_load_dwordx4 v214, s[32:35], s55 offen offset:3072 lds
    ds_read_b64_tr_b16 v[184:185], v213 offset:11264
    ds_read_b64_tr_b16 v[186:187], v213 offset:11520
    s_waitcnt lgkmcnt(14)
    v_mfma_f32_32x32x16_bf16 v[156:171], v[188:191], v[28:31], v[156:171]
    s_lshr_b32 s60, s50, 2
    s_lshl_b32 s60, s60, 19
    s_and_b32 s61, s50, 3
    s_lshl_b32 s61, s61, 11
    s_add_u32 s60, s60, s61
    s_add_u32 s60, s60, s51
    s_add_u32 s50, s50, 1
    ds_read_b64_tr_b16 v[188:189], v213 offset:12288
    ds_read_b64_tr_b16 v[190:191], v213 offset:12544
    s_waitcnt lgkmcnt(14)
    v_mfma_f32_32x32x16_bf16 v[156:171], v[192:195], v[32:35], v[156:171]
    v_cvt_pk_bf16_f32 v204, v140, v141
    ds_read_b64_tr_b16 v[192:193], v213 offset:13312
    ds_read_b64_tr_b16 v[194:195], v213 offset:13568
    s_waitcnt lgkmcnt(14)
    v_mfma_f32_32x32x16_bf16 v[156:171], v[196:199], v[36:39], v[156:171]
    v_cvt_pk_bf16_f32 v205, v142, v143
    ds_read_b64_tr_b16 v[196:197], v213 offset:14336
    ds_read_b64_tr_b16 v[198:199], v213 offset:14592
    s_waitcnt lgkmcnt(14)
    v_mfma_f32_32x32x16_bf16 v[156:171], v[200:203], v[40:43], v[156:171]
    v_cvt_pk_bf16_f32 v206, v144, v145
    ds_read_b64_tr_b16 v[200:201], v213 offset:15360
    ds_read_b64_tr_b16 v[202:203], v213 offset:15616
    s_waitcnt lgkmcnt(14)
    v_mfma_f32_32x32x16_bf16 v[156:171], v[172:175], v[44:47], v[156:171]
    v_cvt_pk_bf16_f32 v207, v146, v147
    ds_read_b64_tr_b16 v[172:173], v213 offset:16384
    ds_read_b64_tr_b16 v[174:175], v213 offset:16640
    s_waitcnt lgkmcnt(14)
    v_mfma_f32_32x32x16_bf16 v[156:171], v[176:179], v[48:51], v[156:171]
    v_cvt_pk_bf16_f32 v208, v148, v149
    ds_read_b64_tr_b16 v[176:177], v213 offset:17408
    ds_read_b64_tr_b16 v[178:179], v213 offset:17664
    s_waitcnt lgkmcnt(14)
    v_mfma_f32_32x32x16_bf16 v[156:171], v[180:183], v[52:55], v[156:171]
    v_cvt_pk_bf16_f32 v209, v150, v151
    ds_read_b64_tr_b16 v[180:181], v213 offset:18432
    ds_read_b64_tr_b16 v[182:183], v213 offset:18688
    s_waitcnt lgkmcnt(14)
    v_mfma_f32_32x32x16_bf16 v[156:171], v[184:187], v[56:59], v[156:171]
    v_cvt_pk_bf16_f32 v210, v152, v153
    ds_read_b64_tr_b16 v[184:185], v213 offset:19456
    ds_read_b64_tr_b16 v[186:187], v213 offset:19712
    s_waitcnt lgkmcnt(14)
    v_mfma_f32_32x32x16_bf16 v[156:171], v[188:191], v[60:63], v[156:171]
    v_cvt_pk_bf16_f32 v211, v154, v155
    ds_read_b64_tr_b16 v[188:189], v213 offset:20480
    ds_read_b64_tr_b16 v[190:191], v213 offset:20736
    s_waitcnt lgkmcnt(14)
    v_mfma_f32_32x32x16_bf16 v[156:171], v[192:195], v[64:67], v[156:171]
    buffer_store_dwordx4 v[204:207], v215, s[36:39], s60 offen
    ds_read_b64_tr_b16 v[192:193], v213 offset:21504
    ds_read_b64_tr_b16 v[194:195], v213 offset:21760
    s_waitcnt lgkmcnt(14)
    v_mfma_f32_32x32x16_bf16 v[156:171], v[196:199], v[68:71], v[156:171]
    buffer_store_dwordx4 v[208:211], v215, s[36:39], s60 offen offset:1024
    ds_read_b64_tr_b16 v[196:197], v213 offset:22528
    ds_read_b64_tr_b16 v[198:199], v213 offset:22784
    s_waitcnt lgkmcnt(14)
    v_mfma_f32_32x32x16_bf16 v[156:171], v[200:203], v[72:75], v[156:171]
    ds_read_b64_tr_b16 v[200:201], v213 offset:23552
    ds_read_b64_tr_b16 v[202:203], v213 offset:23808
    s_waitcnt lgkmcnt(14)
    v_mfma_f32_32x32x16_bf16 v[156:171], v[172:175], v[76:79], v[156:171]
    ds_read_b64_tr_b16 v[172:173], v213 offset:24576
    ds_read_b64_tr_b16 v[174:175], v213 offset:24832
    s_waitcnt lgkmcnt(14)
    v_mfma_f32_32x32x16_bf16 v[156:171], v[176:179], v[80:83], v[156:171]
    ds_read_b64_tr_b16 v[176:177], v213 offset:25600
    ds_read_b64_tr_b16 v[178:179], v213 offset:25856
    s_waitcnt lgkmcnt(14)
    v_mfma_f32_32x32x16_bf16 v[156:171], v[180:183], v[84:87], v[156:171]
    ds_read_b64_tr_b16 v[180:181], v213 offset:26624
    ds_read_b64_tr_b16 v[182:183], v213 offset:26880
    s_waitcnt lgkmcnt(14)
    v_mfma_f32_32x32x16_bf16 v[156:171], v[184:187], v[88:91], v[156:171]
    ds_read_b64_tr_b16 v[184:185], v213 offset:27648
    ds_read_b64_tr_b16 v[186:187], v213 offset:27904
    s_waitcnt lgkmcnt(14)
    v_mfma_f32_32x32x16_bf16 v[156:171], v[188:191], v[92:95], v[156:171]
    ds_read_b64_tr_b16 v[188:189], v213 offset:28672
    ds_read_b64_tr_b16 v[190:191], v213 offset:28928
    s_waitcnt lgkmcnt(14)
    v_mfma_f32_32x32x16_bf16 v[156:171], v[192:195], v[96:99], v[156:171]
    ds_read_b64_tr_b16 v[192:193], v213 offset:29696
    ds_read_b64_tr_b16 v[194:195], v213 offset:29952
    s_waitcnt lgkmcnt(14)
    v_mfma_f32_32x32x16_bf16 v[156:171], v[196:199], v[100:103], v[156:171]
    ds_read_b64_tr_b16 v[196:197], v213 offset:30720
    ds_read_b64_tr_b16 v[198:199], v213 offset:30976
    s_waitcnt lgkmcnt(14)
    v_mfma_f32_32x32x16_bf16 v[156:171], v[200:203], v[104:107], v[156:171]
    ds_read_b64_tr_b16 v[200:201], v213 offset:31744
    ds_read_b64_tr_b16 v[202:203], v213 offset:32000
    s_waitcnt lgkmcnt(14)
    v_mfma_f32_32x32x16_bf16 v[156:171], v[172:175], v[108:111], v[156:171]
    ds_read_b64_tr_b16 v[172:173], v212
    ds_read_b64_tr_b16 v[174:175], v212 offset:256
    s_waitcnt lgkmcnt(14)
    v_mfma_f32_32x32x16_bf16 v[156:171], v[176:179], v[112:115], v[156:171]
    ds_read_b64_tr_b16 v[176:177], v212 offset:1024
    ds_read_b64_tr_b16 v[178:179], v212 offset:1280
    s_waitcnt lgkmcnt(14)
    v_mfma_f32_32x32x16_bf16 v[156:171], v[180:183], v[116:119], v[156:171]
    ds_read_b64_tr_b16 v[180:181], v212 offset:2048
    ds_read_b64_tr_b16 v[182:183], v212 offset:2304
    s_waitcnt lgkmcnt(14)
    v_mfma_f32_32x32x16_bf16 v[156:171], v[184:187], v[120:123], v[156:171]
    ds_read_b64_tr_b16 v[184:185], v212 offset:3072
    ds_read_b64_tr_b16 v[186:187], v212 offset:3328
    s_waitcnt lgkmcnt(14)
    v_mfma_f32_32x32x16_bf16 v[156:171], v[188:191], v[124:127], v[156:171]
    ds_read_b64_tr_b16 v[188:189], v212 offset:4096
    ds_read_b64_tr_b16 v[190:191], v212 offset:4352
    s_waitcnt lgkmcnt(14)
    v_mfma_f32_32x32x16_bf16 v[156:171], v[192:195], v[128:131], v[156:171]
    ds_read_b64_tr_b16 v[192:193], v212 offset:5120
    ds_read_b64_tr_b16 v[194:195], v212 offset:5376
    s_waitcnt lgkmcnt(14)
    v_mfma_f32_32x32x16_bf16 v[156:171], v[196:199], v[132:135], v[156:171]
    ds_read_b64_tr_b16 v[196:197], v212 offset:6144
    ds_read_b64_tr_b16 v[198:199], v212 offset:6400
    s_waitcnt lgkmcnt(14)
    v_mfma_f32_32x32x16_bf16 v[156:171], v[200:203], v[136:139], v[156:171]
    s_add_u32 s48, s48, 32768
    s_and_b32 s48, s48, 131071
    v_add_u32 v213, s48, v7
    s_sub_u32 s49, s49, 1
    s_cmp_eq_u32 s49, 0
    s_cbranch_scc1 proj_qk_endB
    s_waitcnt vmcnt(6)
    s_barrier
    s_cmp_gt_i32 s46, 0
    s_cselect_b32 s57, s45, s63
    s_sub_u32 s46, s46, 1
    s_add_u32 s58, s47, s59
    s_mov_b32 m0, s58
    s_add_u32 s53, s57, 130048
    s_add_u32 s54, s57, 260096
    s_add_u32 s55, s57, 390144
    s_add_u32 s45, s45, 64
    s_add_u32 s47, s47, 32768
    s_and_b32 s47, s47, 131071
    ds_read_b64_tr_b16 v[200:201], v212 offset:7168
    ds_read_b64_tr_b16 v[202:203], v212 offset:7424
    s_waitcnt lgkmcnt(14)
    v_mfma_f32_32x32x16_bf16 v[140:155], v[172:175], v[12:15], 0
    buffer_load_dwordx4 v214, s[32:35], s57 offen lds
    ds_read_b64_tr_b16 v[172:173], v212 offset:8192
    ds_read_b64_tr_b16 v[174:175], v212 offset:8448
    s_waitcnt lgkmcnt(14)
    v_mfma_f32_32x32x16_bf16 v[140:155], v[176:179], v[16:19], v[140:155]
    buffer_load_dwordx4 v214, s[32:35], s53 offen offset:1024 lds
    ds_read_b64_tr_b16 v[176:177], v212 offset:9216
    ds_read_b64_tr_b16 v[178:179], v212 offset:9472
    s_waitcnt lgkmcnt(14)
    v_mfma_f32_32x32x16_bf16 v[140:155], v[180:183], v[20:23], v[140:155]
    buffer_load_dwordx4 v214, s[32:35], s54 offen offset:2048 lds
    ds_read_b64_tr_b16 v[180:181], v212 offset:10240
    ds_read_b64_tr_b16 v[182:183], v212 offset:10496
    s_waitcnt lgkmcnt(14)
    v_mfma_f32_32x32x16_bf16 v[140:155], v[184:187], v[24:27], v[140:155]
    buffer_load_dwordx4 v214, s[32:35], s55 offen offset:3072 lds
    ds_read_b64_tr_b16 v[184:185], v212 offset:11264
    ds_read_b64_tr_b16 v[186:187], v212 offset:11520
    s_waitcnt lgkmcnt(14)
    v_mfma_f32_32x32x16_bf16 v[140:155], v[188:191], v[28:31], v[140:155]
    s_lshr_b32 s60, s50, 2
    s_lshl_b32 s60, s60, 19
    s_and_b32 s61, s50, 3
    s_lshl_b32 s61, s61, 11
    s_add_u32 s60, s60, s61
    s_add_u32 s60, s60, s51
    s_add_u32 s50, s50, 1
    ds_read_b64_tr_b16 v[188:189], v212 offset:12288
    ds_read_b64_tr_b16 v[190:191], v212 offset:12544
    s_waitcnt lgkmcnt(14)
    v_mfma_f32_32x32x16_bf16 v[140:155], v[192:195], v[32:35], v[140:155]
    v_cvt_pk_bf16_f32 v204, v156, v157
    ds_read_b64_tr_b16 v[192:193], v212 offset:13312
    ds_read_b64_tr_b16 v[194:195], v212 offset:13568
    s_waitcnt lgkmcnt(14)
    v_mfma_f32_32x32x16_bf16 v[140:155], v[196:199], v[36:39], v[140:155]
    v_cvt_pk_bf16_f32 v205, v158, v159
    ds_read_b64_tr_b16 v[196:197], v212 offset:14336
    ds_read_b64_tr_b16 v[198:199], v212 offset:14592
    s_waitcnt lgkmcnt(14)
    v_mfma_f32_32x32x16_bf16 v[140:155], v[200:203], v[40:43], v[140:155]
    v_cvt_pk_bf16_f32 v206, v160, v161
    ds_read_b64_tr_b16 v[200:201], v212 offset:15360
    ds_read_b64_tr_b16 v[202:203], v212 offset:15616
    s_waitcnt lgkmcnt(14)
    v_mfma_f32_32x32x16_bf16 v[140:155], v[172:175], v[44:47], v[140:155]
    v_cvt_pk_bf16_f32 v207, v162, v163
    ds_read_b64_tr_b16 v[172:173], v212 offset:16384
    ds_read_b64_tr_b16 v[174:175], v212 offset:16640
    s_waitcnt lgkmcnt(14)
    v_mfma_f32_32x32x16_bf16 v[140:155], v[176:179], v[48:51], v[140:155]
    v_cvt_pk_bf16_f32 v208, v164, v165
    ds_read_b64_tr_b16 v[176:177], v212 offset:17408
    ds_read_b64_tr_b16 v[178:179], v212 offset:17664
    s_waitcnt lgkmcnt(14)
    v_mfma_f32_32x32x16_bf16 v[140:155], v[180:183], v[52:55], v[140:155]
    v_cvt_pk_bf16_f32 v209, v166, v167
    ds_read_b64_tr_b16 v[180:181], v212 offset:18432
    ds_read_b64_tr_b16 v[182:183], v212 offset:18688
    s_waitcnt lgkmcnt(14)
    v_mfma_f32_32x32x16_bf16 v[140:155], v[184:187], v[56:59], v[140:155]
    v_cvt_pk_bf16_f32 v210, v168, v169
    ds_read_b64_tr_b16 v[184:185], v212 offset:19456
    ds_read_b64_tr_b16 v[186:187], v212 offset:19712
    s_waitcnt lgkmcnt(14)
    v_mfma_f32_32x32x16_bf16 v[140:155], v[188:191], v[60:63], v[140:155]
    v_cvt_pk_bf16_f32 v211, v170, v171
    ds_read_b64_tr_b16 v[188:189], v212 offset:20480
    ds_read_b64_tr_b16 v[190:191], v212 offset:20736
    s_waitcnt lgkmcnt(14)
    v_mfma_f32_32x32x16_bf16 v[140:155], v[192:195], v[64:67], v[140:155]
    buffer_store_dwordx4 v[204:207], v215, s[36:39], s60 offen
    ds_read_b64_tr_b16 v[192:193], v212 offset:21504
    ds_read_b64_tr_b16 v[194:195], v212 offset:21760
    s_waitcnt lgkmcnt(14)
    v_mfma_f32_32x32x16_bf16 v[140:155], v[196:199], v[68:71], v[140:155]
    buffer_store_dwordx4 v[208:211], v215, s[36:39], s60 offen offset:1024
    ds_read_b64_tr_b16 v[196:197], v212 offset:22528
    ds_read_b64_tr_b16 v[198:199], v212 offset:22784
    s_waitcnt lgkmcnt(14)
    v_mfma_f32_32x32x16_bf16 v[140:155], v[200:203], v[72:75], v[140:155]
    ds_read_b64_tr_b16 v[200:201], v212 offset:23552
    ds_read_b64_tr_b16 v[202:203], v212 offset:23808
    s_waitcnt lgkmcnt(14)
    v_mfma_f32_32x32x16_bf16 v[140:155], v[172:175], v[76:79], v[140:155]
    ds_read_b64_tr_b16 v[172:173], v212 offset:24576
    ds_read_b64_tr_b16 v[174:175], v212 offset:24832
    s_waitcnt lgkmcnt(14)
    v_mfma_f32_32x32x16_bf16 v[140:155], v[176:179], v[80:83], v[140:155]
    ds_read_b64_tr_b16 v[176:177], v212 offset:25600
    ds_read_b64_tr_b16 v[178:179], v212 offset:25856
    s_waitcnt lgkmcnt(14)
    v_mfma_f32_32x32x16_bf16 v[140:155], v[180:183], v[84:87], v[140:155]
    ds_read_b64_tr_b16 v[180:181], v212 offset:26624
    ds_read_b64_tr_b16 v[182:183], v212 offset:26880
    s_waitcnt lgkmcnt(14)
    v_mfma_f32_32x32x16_bf16 v[140:155], v[184:187], v[88:91], v[140:155]
    ds_read_b64_tr_b16 v[184:185], v212 offset:27648
    ds_read_b64_tr_b16 v[186:187], v212 offset:27904
    s_waitcnt lgkmcnt(14)
    v_mfma_f32_32x32x16_bf16 v[140:155], v[188:191], v[92:95], v[140:155]
    ds_read_b64_tr_b16 v[188:189], v212 offset:28672
    ds_read_b64_tr_b16 v[190:191], v212 offset:28928
    s_waitcnt lgkmcnt(14)
    v_mfma_f32_32x32x16_bf16 v[140:155], v[192:195], v[96:99], v[140:155]
    ds_read_b64_tr_b16 v[192:193], v212 offset:29696
    ds_read_b64_tr_b16 v[194:195], v212 offset:29952
    s_waitcnt lgkmcnt(14)
    v_mfma_f32_32x32x16_bf16 v[140:155], v[196:199], v[100:103], v[140:155]
    ds_read_b64_tr_b16 v[196:197], v212 offset:30720
    ds_read_b64_tr_b16 v[198:199], v212 offset:30976
    s_waitcnt lgkmcnt(14)
    v_mfma_f32_32x32x16_bf16 v[140:155], v[200:203], v[104:107], v[140:155]
    ds_read_b64_tr_b16 v[200:201], v212 offset:31744
    ds_read_b64_tr_b16 v[202:203], v212 offset:32000
    s_waitcnt lgkmcnt(14)
    v_mfma_f32_32x32x16_bf16 v[140:155], v[172:175], v[108:111], v[140:155]
    ds_read_b64_tr_b16 v[172:173], v213
    ds_read_b64_tr_b16 v[174:175], v213 offset:256
    s_waitcnt lgkmcnt(14)
    v_mfma_f32_32x32x16_bf16 v[140:155], v[176:179], v[112:115], v[140:155]
    ds_read_b64_tr_b16 v[176:177], v213 offset:1024
    ds_read_b64_tr_b16 v[178:179], v213 offset:1280
    s_waitcnt lgkmcnt(14)
    v_mfma_f32_32x32x16_bf16 v[140:155], v[180:183], v[116:119], v[140:155]
    ds_read_b64_tr_b16 v[180:181], v213 offset:2048
    ds_read_b64_tr_b16 v[182:183], v213 offset:2304
    s_waitcnt lgkmcnt(14)
    v_mfma_f32_32x32x16_bf16 v[140:155], v[184:187], v[120:123], v[140:155]
    ds_read_b64_tr_b16 v[184:185], v213 offset:3072
    ds_read_b64_tr_b16 v[186:187], v213 offset:3328
    s_waitcnt lgkmcnt(14)
    v_mfma_f32_32x32x16_bf16 v[140:155], v[188:191], v[124:127], v[140:155]
    ds_read_b64_tr_b16 v[188:189], v213 offset:4096
    ds_read_b64_tr_b16 v[190:191], v213 offset:4352
    s_waitcnt lgkmcnt(14)
    v_mfma_f32_32x32x16_bf16 v[140:155], v[192:195], v[128:131], v[140:155]
    ds_read_b64_tr_b16 v[192:193], v213 offset:5120
    ds_read_b64_tr_b16 v[194:195], v213 offset:5376
    s_waitcnt lgkmcnt(14)
    v_mfma_f32_32x32x16_bf16 v[140:155], v[196:199], v[132:135], v[140:155]
    ds_read_b64_tr_b16 v[196:197], v213 offset:6144
    ds_read_b64_tr_b16 v[198:199], v213 offset:6400
    s_waitcnt lgkmcnt(14)
    v_mfma_f32_32x32x16_bf16 v[140:155], v[200:203], v[136:139], v[140:155]
    s_add_u32 s48, s48, 32768
    s_and_b32 s48, s48, 131071
    v_add_u32 v212, s48, v7
    s_sub_u32 s49, s49, 1
    s_cmp_lg_u32 s49, 0
    s_cbranch_scc1 proj_qk_loop
proj_qk_endA:
    s_nop 15
    s_lshr_b32 s60, s50, 2
    s_lshl_b32 s60, s60, 19
    s_and_b32 s61, s50, 3
    s_lshl_b32 s61, s61, 11
    s_add_u32 s60, s60, s61
    s_add_u32 s60, s60, s51
    s_add_u32 s50, s50, 1
    v_cvt_pk_bf16_f32 v204, v140, v141
    v_cvt_pk_bf16_f32 v205, v142, v143
    v_cvt_pk_bf16_f32 v206, v144, v145
    v_cvt_pk_bf16_f32 v207, v146, v147
    v_cvt_pk_bf16_f32 v208, v148, v149
    v_cvt_pk_bf16_f32 v209, v150, v151
    v_cvt_pk_bf16_f32 v210, v152, v153
    v_cvt_pk_bf16_f32 v211, v154, v155
    buffer_store_dwordx4 v[204:207], v215, s[36:39], s60 offen
    buffer_store_dwordx4 v[208:211], v215, s[36:39], s60 offen offset:1024
    s_waitcnt vmcnt(0)
    s_branch proj_end
proj_qk_endB:
    s_nop 15
    s_lshr_b32 s60, s50, 2
    s_lshl_b32 s60, s60, 19
    s_and_b32 s61, s50, 3
    s_lshl_b32 s61, s61, 11
    s_add_u32 s60, s60, s61
    s_add_u32 s60, s60, s51
    s_add_u32 s50, s50, 1
    v_cvt_pk_bf16_f32 v204, v156, v157
    v_cvt_pk_bf16_f32 v205, v158, v159
    v_cvt_pk_bf16_f32 v206, v160, v161
    v_cvt_pk_bf16_f32 v207, v162, v163
    v_cvt_pk_bf16_f32 v208, v164, v165
    v_cvt_pk_bf16_f32 v209, v166, v167
    v_cvt_pk_bf16_f32 v210, v168, v169
    v_cvt_pk_bf16_f32 v211, v170, v171
    buffer_store_dwordx4 v[204:207], v215, s[36:39], s60 offen
    buffer_store_dwordx4 v[208:211], v215, s[36:39], s60 offen offset:1024
    s_waitcnt vmcnt(0)
    s_branch proj_end
proj_type_v:
    v_lshrrev_b32 v6, 2, v2
    s_mov_b32 s21, 8192
    v_mul_lo_u32 v214, v6, s21
    v_and_b32 v6, 3, v2
    v_lshlrev_b32 v6, 4, v6
    v_add_u32 v214, v214, v6
    s_lshl_b32 s21, s19, 3
    s_add_u32 s21, s21, s18
    s_mul_i32 s21, s21, 8192
    v_lshlrev_b32 v215, 4, v2
    v_add_u32 v215, s21, v215
    s_mul_i32 s45, s18, 524288
    s_lshl_b32 s21, s25, 6
    s_add_u32 s45, s45, s21
    s_mov_b32 s46, s26
    s_mov_b32 s47, 0
    s_mov_b32 s48, 0
    s_mov_b32 s50, s25
    s_mov_b32 s51, 0x2000000
    s_cmp_gt_i32 s46, 0
    s_cselect_b32 s57, s45, s63
    s_sub_u32 s46, s46, 1
    s_add_u32 s58, s47, s59
    s_mov_b32 m0, s58
    s_add_u32 s53, s57, 130048
    s_add_u32 s54, s57, 260096
    s_add_u32 s55, s57, 390144
    s_add_u32 s45, s45, 64
    s_add_u32 s47, s47, 32768
    s_and_b32 s47, s47, 131071
    buffer_load_dwordx4 v214, s[32:35], s57 offen lds
    buffer_load_dwordx4 v214, s[32:35], s53 offen offset:1024 lds
    buffer_load_dwordx4 v214, s[32:35], s54 offen offset:2048 lds
    buffer_load_dwordx4 v214, s[32:35], s55 offen offset:3072 lds
    s_cmp_gt_i32 s46, 0
    s_cselect_b32 s57, s45, s63
    s_sub_u32 s46, s46, 1
    s_add_u32 s58, s47, s59
    s_mov_b32 m0, s58
    s_add_u32 s53, s57, 130048
    s_add_u32 s54, s57, 260096
    s_add_u32 s55, s57, 390144
    s_add_u32 s45, s45, 64
    s_add_u32 s47, s47, 32768
    s_and_b32 s47, s47, 131071
    buffer_load_dwordx4 v214, s[32:35], s57 offen lds
    buffer_load_dwordx4 v214, s[32:35], s53 offen offset:1024 lds
    buffer_load_dwordx4 v214, s[32:35], s54 offen offset:2048 lds
    buffer_load_dwordx4 v214, s[32:35], s55 offen offset:3072 lds
    s_cmp_gt_i32 s46, 0
    s_cselect_b32 s57, s45, s63
    s_sub_u32 s46, s46, 1
    s_add_u32 s58, s47, s59
    s_mov_b32 m0, s58
    s_add_u32 s53, s57, 130048
    s_add_u32 s54, s57, 260096
    s_add_u32 s55, s57, 390144
    s_add_u32 s45, s45, 64
    s_add_u32 s47, s47, 32768
    s_and_b32 s47, s47, 131071
    buffer_load_dwordx4 v214, s[32:35], s57 offen lds
    buffer_load_dwordx4 v214, s[32:35], s53 offen offset:1024 lds
    buffer_load_dwordx4 v214, s[32:35], s54 offen offset:2048 lds
    buffer_load_dwordx4 v214, s[32:35], s55 offen offset:3072 lds
    s_lshl_b32 s21, s19, 3
    s_add_u32 s21, s21, s18
    s_lshl_b32 s21, s21, 15
    s_add_u32 s21, s21, s44
    s_mov_b32 s56, s21
    buffer_load_dwordx4 v[12:15], v5, s[36:39], s56 offen
    buffer_load_dwordx4 v[16:19], v5, s[36:39], s56 offen offset:1024
    buffer_load_dwordx4 v[20:23], v5, s[36:39], s56 offen offset:2048
    buffer_load_dwordx4 v[24:27], v5, s[36:39], s56 offen offset:3072
    s_add_u32 s56, s56, 4096
    buffer_load_dwordx4 v[28:31], v5, s[36:39], s56 offen
    buffer_load_dwordx4 v[32:35], v5, s[36:39], s56 offen offset:1024
    buffer_load_dwordx4 v[36:39], v5, s[36:39], s56 offen offset:2048
    buffer_load_dwordx4 v[40:43], v5, s[36:39], s56 offen offset:3072
    s_waitcnt vmcnt(8)
    s_barrier
    v_mov_b32 v212, v7
    v_add_u32 v213, 32768, v7
    s_mov_b32 s48, 32768
    ds_read_b64_tr_b16 v[172:173], v212
    ds_read_b64_tr_b16 v[174:175], v212 offset:256
    ds_read_b64_tr_b16 v[176:177], v212 offset:1024
    ds_read_b64_tr_b16 v[178:179], v212 offset:1280
    ds_read_b64_tr_b16 v[180:181], v212 offset:2048
    ds_read_b64_tr_b16 v[182:183], v212 offset:2304
    ds_read_b64_tr_b16 v[184:185], v212 offset:3072
    ds_read_b64_tr_b16 v[186:187], v212 offset:3328
    ds_read_b64_tr_b16 v[188:189], v212 offset:4096
    ds_read_b64_tr_b16 v[190:191], v212 offset:4352
    ds_read_b64_tr_b16 v[192:193], v212 offset:5120
    ds_read_b64_tr_b16 v[194:195], v212 offset:5376
    ds_read_b64_tr_b16 v[196:197], v212 offset:6144
    ds_read_b64_tr_b16 v[198:199], v212 offset:6400
    s_cmp_gt_i32 s46, 0
    s_cselect_b32 s57, s45, s63
    s_sub_u32 s46, s46, 1
    s_add_u32 s58, s47, s59
    s_mov_b32 m0, s58
    s_add_u32 s53, s57, 130048
    s_add_u32 s54, s57, 260096
    s_add_u32 s55, s57, 390144
    s_add_u32 s45, s45, 64
    s_add_u32 s47, s47, 32768
    s_and_b32 s47, s47, 131071
    ds_read_b64_tr_b16 v[200:201], v212 offset:7168
    ds_read_b64_tr_b16 v[202:203], v212 offset:7424
    s_waitcnt lgkmcnt(14)
    s_add_u32 s56, s56, 4096
    buffer_load_dwordx4 v[44:47], v5, s[36:39], s56 offen
    s_waitcnt vmcnt(8)
    v_mfma_f32_32x32x16_bf16 v[140:155], v[12:15], v[172:175], 0
    buffer_load_dwordx4 v214, s[32:35], s57 offen lds
    ds_read_b64_tr_b16 v[172:173], v212 offset:8192
    ds_read_b64_tr_b16 v[174:175], v212 offset:8448
    s_waitcnt lgkmcnt(14)
    buffer_load_dwordx4 v[48:51], v5, s[36:39], s56 offen offset:1024
    s_waitcnt vmcnt(9)
    v_mfma_f32_32x32x16_bf16 v[140:155], v[16:19], v[176:179], v[140:155]
    buffer_load_dwordx4 v214, s[32:35], s53 offen offset:1024 lds
    ds_read_b64_tr_b16 v[176:177], v212 offset:9216
    ds_read_b64_tr_b16 v[178:179], v212 offset:9472
    s_waitcnt lgkmcnt(14)
    buffer_load_dwordx4 v[52:55], v5, s[36:39], s56 offen offset:2048
    s_waitcnt vmcnt(10)
    v_mfma_f32_32x32x16_bf16 v[140:155], v[20:23], v[180:183], v[140:155]
    buffer_load_dwordx4 v214, s[32:35], s54 offen offset:2048 lds
    ds_read_b64_tr_b16 v[180:181], v212 offset:10240
    ds_read_b64_tr_b16 v[182:183], v212 offset:10496
    s_waitcnt lgkmcnt(14)
    buffer_load_dwordx4 v[56:59], v5, s[36:39], s56 offen offset:3072
    s_waitcnt vmcnt(11)
    v_mfma_f32_32x32x16_bf16 v[140:155], v[24:27], v[184:187], v[140:155]
    buffer_load_dwordx4 v214, s[32:35], s55 offen offset:3072 lds
    ds_read_b64_tr_b16 v[184:185], v212 offset:11264
    ds_read_b64_tr_b16 v[186:187], v212 offset:11520
    s_waitcnt lgkmcnt(14)
    s_add_u32 s56, s56, 4096
    buffer_load_dwordx4 v[60:63], v5, s[36:39], s56 offen
    s_waitcnt vmcnt(12)
    v_mfma_f32_32x32x16_bf16 v[140:155], v[28:31], v[188:191], v[140:155]
    ds_read_b64_tr_b16 v[188:189], v212 offset:12288
    ds_read_b64_tr_b16 v[190:191], v212 offset:12544
    s_waitcnt lgkmcnt(14)
    buffer_load_dwordx4 v[64:67], v5, s[36:39], s56 offen offset:1024
    s_waitcnt vmcnt(12)
    v_mfma_f32_32x32x16_bf16 v[140:155], v[32:35], v[192:195], v[140:155]
    ds_read_b64_tr_b16 v[192:193], v212 offset:13312
    ds_read_b64_tr_b16 v[194:195], v212 offset:13568
    s_waitcnt lgkmcnt(14)
    buffer_load_dwordx4 v[68:71], v5, s[36:39], s56 offen offset:2048
    s_waitcnt vmcnt(12)
    v_mfma_f32_32x32x16_bf16 v[140:155], v[36:39], v[196:199], v[140:155]
    ds_read_b64_tr_b16 v[196:197], v212 offset:14336
    ds_read_b64_tr_b16 v[198:199], v212 offset:14592
    s_waitcnt lgkmcnt(14)
    buffer_load_dwordx4 v[72:75], v5, s[36:39], s56 offen offset:3072
    s_waitcnt vmcnt(12)
    v_mfma_f32_32x32x16_bf16 v[140:155], v[40:43], v[200:203], v[140:155]
    ds_read_b64_tr_b16 v[200:201], v212 offset:15360
    ds_read_b64_tr_b16 v[202:203], v212 offset:15616
    s_waitcnt lgkmcnt(14)
    s_add_u32 s56, s56, 4096
    buffer_load_dwordx4 v[76:79], v5, s[36:39], s56 offen
    s_waitcnt vmcnt(12)
    v_mfma_f32_32x32x16_bf16 v[140:155], v[44:47], v[172:175], v[140:155]
    ds_read_b64_tr_b16 v[172:173], v212 offset:16384
    ds_read_b64_tr_b16 v[174:175], v212 offset:16640
    s_waitcnt lgkmcnt(14)
    buffer_load_dwordx4 v[80:83], v5, s[36:39], s56 offen offset:1024
    s_waitcnt vmcnt(11)
    v_mfma_f32_32x32x16_bf16 v[140:155], v[48:51], v[176:179], v[140:155]
    ds_read_b64_tr_b16 v[176:177], v212 offset:17408
    ds_read_b64_tr_b16 v[178:179], v212 offset:17664
    s_waitcnt lgkmcnt(14)
    buffer_load_dwordx4 v[84:87], v5, s[36:39], s56 offen offset:2048
    s_waitcnt vmcnt(10)
    v_mfma_f32_32x32x16_bf16 v[140:155], v[52:55], v[180:183], v[140:155]
    ds_read_b64_tr_b16 v[180:181], v212 offset:18432
    ds_read_b64_tr_b16 v[182:183], v212 offset:18688
    s_waitcnt lgkmcnt(14)
    buffer_load_dwordx4 v[88:91], v5, s[36:39], s56 offen offset:3072
    s_waitcnt vmcnt(9)
    v_mfma_f32_32x32x16_bf16 v[140:155], v[56:59], v[184:187], v[140:155]
    ds_read_b64_tr_b16 v[184:185], v212 offset:19456
    ds_read_b64_tr_b16 v[186:187], v212 offset:19712
    s_waitcnt lgkmcnt(14)
    s_add_u32 s56, s56, 4096
    buffer_load_dwordx4 v[92:95], v5, s[36:39], s56 offen
    s_waitcnt vmcnt(8)
    v_mfma_f32_32x32x16_bf16 v[140:155], v[60:63], v[188:191], v[140:155]
    ds_read_b64_tr_b16 v[188:189], v212 offset:20480
    ds_read_b64_tr_b16 v[190:191], v212 offset:20736
    s_waitcnt lgkmcnt(14)
    buffer_load_dwordx4 v[96:99], v5, s[36:39], s56 offen offset:1024
    s_waitcnt vmcnt(8)
    v_mfma_f32_32x32x16_bf16 v[140:155], v[64:67], v[192:195], v[140:155]
    ds_read_b64_tr_b16 v[192:193], v212 offset:21504
    ds_read_b64_tr_b16 v[194:195], v212 offset:21760
    s_waitcnt lgkmcnt(14)
    buffer_load_dwordx4 v[100:103], v5, s[36:39], s56 offen offset:2048
    s_waitcnt vmcnt(8)
    v_mfma_f32_32x32x16_bf16 v[140:155], v[68:71], v[196:199], v[140:155]
    ds_read_b64_tr_b16 v[196:197], v212 offset:22528
    ds_read_b64_tr_b16 v[198:199], v212 offset:22784
    s_waitcnt lgkmcnt(14)
    buffer_load_dwordx4 v[104:107], v5, s[36:39], s56 offen offset:3072
    s_waitcnt vmcnt(8)
    v_mfma_f32_32x32x16_bf16 v[140:155], v[72:75], v[200:203], v[140:155]
    ds_read_b64_tr_b16 v[200:201], v212 offset:23552
    ds_read_b64_tr_b16 v[202:203], v212 offset:23808
    s_waitcnt lgkmcnt(14)
    s_add_u32 s56, s56, 4096
    buffer_load_dwordx4 v[108:111], v5, s[36:39], s56 offen
    s_waitcnt vmcnt(8)
    v_mfma_f32_32x32x16_bf16 v[140:155], v[76:79], v[172:175], v[140:155]
    ds_read_b64_tr_b16 v[172:173], v212 offset:24576
    ds_read_b64_tr_b16 v[174:175], v212 offset:24832
    s_waitcnt lgkmcnt(14)
    buffer_load_dwordx4 v[112:115], v5, s[36:39], s56 offen offset:1024
    s_waitcnt vmcnt(8)
    v_mfma_f32_32x32x16_bf16 v[140:155], v[80:83], v[176:179], v[140:155]
    ds_read_b64_tr_b16 v[176:177], v212 offset:25600
    ds_read_b64_tr_b16 v[178:179], v212 offset:25856
    s_waitcnt lgkmcnt(14)
    buffer_load_dwordx4 v[116:119], v5, s[36:39], s56 offen offset:2048
    s_waitcnt vmcnt(8)
    v_mfma_f32_32x32x16_bf16 v[140:155], v[84:87], v[180:183], v[140:155]
    ds_read_b64_tr_b16 v[180:181], v212 offset:26624
    ds_read_b64_tr_b16 v[182:183], v212 offset:26880
    s_waitcnt lgkmcnt(14)
    buffer_load_dwordx4 v[120:123], v5, s[36:39], s56 offen offset:3072
    s_waitcnt vmcnt(8)
    v_mfma_f32_32x32x16_bf16 v[140:155], v[88:91], v[184:187], v[140:155]
    ds_read_b64_tr_b16 v[184:185], v212 offset:27648
    ds_read_b64_tr_b16 v[186:187], v212 offset:27904
    s_waitcnt lgkmcnt(14)
    s_add_u32 s56, s56, 4096
    buffer_load_dwordx4 v[124:127], v5, s[36:39], s56 offen
    s_waitcnt vmcnt(8)
    v_mfma_f32_32x32x16_bf16 v[140:155], v[92:95], v[188:191], v[140:155]
    ds_read_b64_tr_b16 v[188:189], v212 offset:28672
    ds_read_b64_tr_b16 v[190:191], v212 offset:28928
    s_waitcnt lgkmcnt(14)
    buffer_load_dwordx4 v[128:131], v5, s[36:39], s56 offen offset:1024
    s_waitcnt vmcnt(8)
    v_mfma_f32_32x32x16_bf16 v[140:155], v[96:99], v[192:195], v[140:155]
    ds_read_b64_tr_b16 v[192:193], v212 offset:29696
    ds_read_b64_tr_b16 v[194:195], v212 offset:29952
    s_waitcnt lgkmcnt(14)
    buffer_load_dwordx4 v[132:135], v5, s[36:39], s56 offen offset:2048
    s_waitcnt vmcnt(8)
    v_mfma_f32_32x32x16_bf16 v[140:155], v[100:103], v[196:199], v[140:155]
    ds_read_b64_tr_b16 v[196:197], v212 offset:30720
    ds_read_b64_tr_b16 v[198:199], v212 offset:30976
    s_waitcnt lgkmcnt(14)
    buffer_load_dwordx4 v[136:139], v5, s[36:39], s56 offen offset:3072
    s_waitcnt vmcnt(8)
    v_mfma_f32_32x32x16_bf16 v[140:155], v[104:107], v[200:203], v[140:155]
    ds_read_b64_tr_b16 v[200:201], v212 offset:31744
    ds_read_b64_tr_b16 v[202:203], v212 offset:32000
    s_waitcnt lgkmcnt(14)
    s_waitcnt vmcnt(7)
    v_mfma_f32_32x32x16_bf16 v[140:155], v[108:111], v[172:175], v[140:155]
    ds_read_b64_tr_b16 v[172:173], v213
    ds_read_b64_tr_b16 v[174:175], v213 offset:256
    s_waitcnt lgkmcnt(14)
    s_waitcnt vmcnt(6)
    v_mfma_f32_32x32x16_bf16 v[140:155], v[112:115], v[176:179], v[140:155]
    ds_read_b64_tr_b16 v[176:177], v213 offset:1024
    ds_read_b64_tr_b16 v[178:179], v213 offset:1280
    s_waitcnt lgkmcnt(14)
    s_waitcnt vmcnt(5)
    v_mfma_f32_32x32x16_bf16 v[140:155], v[116:119], v[180:183], v[140:155]
    ds_read_b64_tr_b16 v[180:181], v213 offset:2048
    ds_read_b64_tr_b16 v[182:183], v213 offset:2304
    s_waitcnt lgkmcnt(14)
    s_waitcnt vmcnt(4)
    v_mfma_f32_32x32x16_bf16 v[140:155], v[120:123], v[184:187], v[140:155]
    ds_read_b64_tr_b16 v[184:185], v213 offset:3072
    ds_read_b64_tr_b16 v[186:187], v213 offset:3328
    s_waitcnt lgkmcnt(14)
    s_waitcnt vmcnt(3)
    v_mfma_f32_32x32x16_bf16 v[140:155], v[124:127], v[188:191], v[140:155]
    ds_read_b64_tr_b16 v[188:189], v213 offset:4096
    ds_read_b64_tr_b16 v[190:191], v213 offset:4352
    s_waitcnt lgkmcnt(14)
    s_waitcnt vmcnt(2)
    v_mfma_f32_32x32x16_bf16 v[140:155], v[128:131], v[192:195], v[140:155]
    ds_read_b64_tr_b16 v[192:193], v213 offset:5120
    ds_read_b64_tr_b16 v[194:195], v213 offset:5376
    s_waitcnt lgkmcnt(14)
    s_waitcnt vmcnt(1)
    v_mfma_f32_32x32x16_bf16 v[140:155], v[132:135], v[196:199], v[140:155]
    ds_read_b64_tr_b16 v[196:197], v213 offset:6144
    ds_read_b64_tr_b16 v[198:199], v213 offset:6400
    s_waitcnt lgkmcnt(14)
    s_waitcnt vmcnt(0)
    v_mfma_f32_32x32x16_bf16 v[140:155], v[136:139], v[200:203], v[140:155]
    s_add_u32 s48, s48, 32768
    s_and_b32 s48, s48, 131071
    v_add_u32 v212, s48, v7
    s_sub_u32 s49, s26, 1
proj_v_loop:
    s_waitcnt vmcnt(6)
    s_barrier
    s_cmp_gt_i32 s46, 0
    s_cselect_b32 s57, s45, s63
    s_sub_u32 s46, s46, 1
    s_add_u32 s58, s47, s59
    s_mov_b32 m0, s58
    s_add_u32 s53, s57, 130048
    s_add_u32 s54, s57, 260096
    s_add_u32 s55, s57, 390144
    s_add_u32 s45, s45, 64
    s_add_u32 s47, s47, 32768
    s_and_b32 s47, s47, 131071
    ds_read_b64_tr_b16 v[200:201], v213 offset:7168
    ds_read_b64_tr_b16 v[202:203], v213 offset:7424
    s_waitcnt lgkmcnt(14)
    v_mfma_f32_32x32x16_bf16 v[156:171], v[12:15], v[172:175], 0
    buffer_load_dwordx4 v214, s[32:35], s57 offen lds
    ds_read_b64_tr_b16 v[172:173], v213 offset:8192
    ds_read_b64_tr_b16 v[174:175], v213 offset:8448
    s_waitcnt lgkmcnt(14)
    v_mfma_f32_32x32x16_bf16 v[156:171], v[16:19], v[176:179], v[156:171]
    buffer_load_dwordx4 v214, s[32:35], s53 offen offset:1024 lds
    ds_read_b64_tr_b16 v[176:177], v213 offset:9216
    ds_read_b64_tr_b16 v[178:179], v213 offset:9472
    s_waitcnt lgkmcnt(14)
    v_mfma_f32_32x32x16_bf16 v[156:171], v[20:23], v[180:183], v[156:171]
    buffer_load_dwordx4 v214, s[32:35], s54 offen offset:2048 lds
    ds_read_b64_tr_b16 v[180:181], v213 offset:10240
    ds_read_b64_tr_b16 v[182:183], v213 offset:10496
    s_waitcnt lgkmcnt(14)
    v_mfma_f32_32x32x16_bf16 v[156:171], v[24:27], v[184:187], v[156:171]
    buffer_load_dwordx4 v214, s[32:35], s55 offen offset:3072 lds
    ds_read_b64_tr_b16 v[184:185], v213 offset:11264
    ds_read_b64_tr_b16 v[186:187], v213 offset:11520
    s_waitcnt lgkmcnt(14)
    v_mfma_f32_32x32x16_bf16 v[156:171], v[28:31], v[188:191], v[156:171]
    s_lshr_b32 s60, s50, 2
    s_lshl_b32 s60, s60, 19
    s_and_b32 s61, s50, 3
    s_lshl_b32 s61, s61, 10
    s_add_u32 s60, s60, s61
    s_add_u32 s60, s60, s51
    s_add_u32 s61, s60, 4096
    s_add_u32 s50, s50, 1
    ds_read_b64_tr_b16 v[188:189], v213 offset:12288
    ds_read_b64_tr_b16 v[190:191], v213 offset:12544
    s_waitcnt lgkmcnt(14)
    v_mfma_f32_32x32x16_bf16 v[156:171], v[32:35], v[192:195], v[156:171]
    v_cvt_pk_bf16_f32 v204, v140, v141
    ds_read_b64_tr_b16 v[192:193], v213 offset:13312
    ds_read_b64_tr_b16 v[194:195], v213 offset:13568
    s_waitcnt lgkmcnt(14)
    v_mfma_f32_32x32x16_bf16 v[156:171], v[36:39], v[196:199], v[156:171]
    v_cvt_pk_bf16_f32 v205, v142, v143
    ds_read_b64_tr_b16 v[196:197], v213 offset:14336
    ds_read_b64_tr_b16 v[198:199], v213 offset:14592
    s_waitcnt lgkmcnt(14)
    v_mfma_f32_32x32x16_bf16 v[156:171], v[40:43], v[200:203], v[156:171]
    v_cvt_pk_bf16_f32 v206, v144, v145
    ds_read_b64_tr_b16 v[200:201], v213 offset:15360
    ds_read_b64_tr_b16 v[202:203], v213 offset:15616
    s_waitcnt lgkmcnt(14)
    v_mfma_f32_32x32x16_bf16 v[156:171], v[44:47], v[172:175], v[156:171]
    v_cvt_pk_bf16_f32 v207, v146, v147
    ds_read_b64_tr_b16 v[172:173], v213 offset:16384
    ds_read_b64_tr_b16 v[174:175], v213 offset:16640
    s_waitcnt lgkmcnt(14)
    v_mfma_f32_32x32x16_bf16 v[156:171], v[48:51], v[176:179], v[156:171]
    v_cvt_pk_bf16_f32 v208, v148, v149
    ds_read_b64_tr_b16 v[176:177], v213 offset:17408
    ds_read_b64_tr_b16 v[178:179], v213 offset:17664
    s_waitcnt lgkmcnt(14)
    v_mfma_f32_32x32x16_bf16 v[156:171], v[52:55], v[180:183], v[156:171]
    v_cvt_pk_bf16_f32 v209, v150, v151
    ds_read_b64_tr_b16 v[180:181], v213 offset:18432
    ds_read_b64_tr_b16 v[182:183], v213 offset:18688
    s_waitcnt lgkmcnt(14)
    v_mfma_f32_32x32x16_bf16 v[156:171], v[56:59], v[184:187], v[156:171]
    v_cvt_pk_bf16_f32 v210, v152, v153
    ds_read_b64_tr_b16 v[184:185], v213 offset:19456
    ds_read_b64_tr_b16 v[186:187], v213 offset:19712
    s_waitcnt lgkmcnt(14)
    v_mfma_f32_32x32x16_bf16 v[156:171], v[60:63], v[188:191], v[156:171]
    v_cvt_pk_bf16_f32 v211, v154, v155
    ds_read_b64_tr_b16 v[188:189], v213 offset:20480
    ds_read_b64_tr_b16 v[190:191], v213 offset:20736
    s_waitcnt lgkmcnt(14)
    v_mfma_f32_32x32x16_bf16 v[156:171], v[64:67], v[192:195], v[156:171]
    buffer_store_dwordx4 v[204:207], v215, s[36:39], s60 offen
    ds_read_b64_tr_b16 v[192:193], v213 offset:21504
    ds_read_b64_tr_b16 v[194:195], v213 offset:21760
    s_waitcnt lgkmcnt(14)
    v_mfma_f32_32x32x16_bf16 v[156:171], v[68:71], v[196:199], v[156:171]
    buffer_store_dwordx4 v[208:211], v215, s[36:39], s61 offen
    ds_read_b64_tr_b16 v[196:197], v213 offset:22528
    ds_read_b64_tr_b16 v[198:199], v213 offset:22784
    s_waitcnt lgkmcnt(14)
    v_mfma_f32_32x32x16_bf16 v[156:171], v[72:75], v[200:203], v[156:171]
    ds_read_b64_tr_b16 v[200:201], v213 offset:23552
    ds_read_b64_tr_b16 v[202:203], v213 offset:23808
    s_waitcnt lgkmcnt(14)
    v_mfma_f32_32x32x16_bf16 v[156:171], v[76:79], v[172:175], v[156:171]
    ds_read_b64_tr_b16 v[172:173], v213 offset:24576
    ds_read_b64_tr_b16 v[174:175], v213 offset:24832
    s_waitcnt lgkmcnt(14)
    v_mfma_f32_32x32x16_bf16 v[156:171], v[80:83], v[176:179], v[156:171]
    ds_read_b64_tr_b16 v[176:177], v213 offset:25600
    ds_read_b64_tr_b16 v[178:179], v213 offset:25856
    s_waitcnt lgkmcnt(14)
    v_mfma_f32_32x32x16_bf16 v[156:171], v[84:87], v[180:183], v[156:171]
    ds_read_b64_tr_b16 v[180:181], v213 offset:26624
    ds_read_b64_tr_b16 v[182:183], v213 offset:26880
    s_waitcnt lgkmcnt(14)
    v_mfma_f32_32x32x16_bf16 v[156:171], v[88:91], v[184:187], v[156:171]
    ds_read_b64_tr_b16 v[184:185], v213 offset:27648
    ds_read_b64_tr_b16 v[186:187], v213 offset:27904
    s_waitcnt lgkmcnt(14)
    v_mfma_f32_32x32x16_bf16 v[156:171], v[92:95], v[188:191], v[156:171]
    ds_read_b64_tr_b16 v[188:189], v213 offset:28672
    ds_read_b64_tr_b16 v[190:191], v213 offset:28928
    s_waitcnt lgkmcnt(14)
    v_mfma_f32_32x32x16_bf16 v[156:171], v[96:99], v[192:195], v[156:171]
    ds_read_b64_tr_b16 v[192:193], v213 offset:29696
    ds_read_b64_tr_b16 v[194:195], v213 offset:29952
    s_waitcnt lgkmcnt(14)
    v_mfma_f32_32x32x16_bf16 v[156:171], v[100:103], v[196:199], v[156:171]
    ds_read_b64_tr_b16 v[196:197], v213 offset:30720
    ds_read_b64_tr_b16 v[198:199], v213 offset:30976
    s_waitcnt lgkmcnt(14)
    v_mfma_f32_32x32x16_bf16 v[156:171], v[104:107], v[200:203], v[156:171]
    ds_read_b64_tr_b16 v[200:201], v213 offset:31744
    ds_read_b64_tr_b16 v[202:203], v213 offset:32000
    s_waitcnt lgkmcnt(14)
    v_mfma_f32_32x32x16_bf16 v[156:171], v[108:111], v[172:175], v[156:171]
    ds_read_b64_tr_b16 v[172:173], v212
    ds_read_b64_tr_b16 v[174:175], v212 offset:256
    s_waitcnt lgkmcnt(14)
    v_mfma_f32_32x32x16_bf16 v[156:171], v[112:115], v[176:179], v[156:171]
    ds_read_b64_tr_b16 v[176:177], v212 offset:1024
    ds_read_b64_tr_b16 v[178:179], v212 offset:1280
    s_waitcnt lgkmcnt(14)
    v_mfma_f32_32x32x16_bf16 v[156:171], v[116:119], v[180:183], v[156:171]
    ds_read_b64_tr_b16 v[180:181], v212 offset:2048
    ds_read_b64_tr_b16 v[182:183], v212 offset:2304
    s_waitcnt lgkmcnt(14)
    v_mfma_f32_32x32x16_bf16 v[156:171], v[120:123], v[184:187], v[156:171]
    ds_read_b64_tr_b16 v[184:185], v212 offset:3072
    ds_read_b64_tr_b16 v[186:187], v212 offset:3328
    s_waitcnt lgkmcnt(14)
    v_mfma_f32_32x32x16_bf16 v[156:171], v[124:127], v[188:191], v[156:171]
    ds_read_b64_tr_b16 v[188:189], v212 offset:4096
    ds_read_b64_tr_b16 v[190:191], v212 offset:4352
    s_waitcnt lgkmcnt(14)
    v_mfma_f32_32x32x16_bf16 v[156:171], v[128:131], v[192:195], v[156:171]
    ds_read_b64_tr_b16 v[192:193], v212 offset:5120
    ds_read_b64_tr_b16 v[194:195], v212 offset:5376
    s_waitcnt lgkmcnt(14)
    v_mfma_f32_32x32x16_bf16 v[156:171], v[132:135], v[196:199], v[156:171]
    ds_read_b64_tr_b16 v[196:197], v212 offset:6144
    ds_read_b64_tr_b16 v[198:199], v212 offset:6400
    s_waitcnt lgkmcnt(14)
    v_mfma_f32_32x32x16_bf16 v[156:171], v[136:139], v[200:203], v[156:171]
    s_add_u32 s48, s48, 32768
    s_and_b32 s48, s48, 131071
    v_add_u32 v213, s48, v7
    s_sub_u32 s49, s49, 1
    s_cmp_eq_u32 s49, 0
    s_cbranch_scc1 proj_v_endB
    s_waitcnt vmcnt(6)
    s_barrier
    s_cmp_gt_i32 s46, 0
    s_cselect_b32 s57, s45, s63
    s_sub_u32 s46, s46, 1
    s_add_u32 s58, s47, s59
    s_mov_b32 m0, s58
    s_add_u32 s53, s57, 130048
    s_add_u32 s54, s57, 260096
    s_add_u32 s55, s57, 390144
    s_add_u32 s45, s45, 64
    s_add_u32 s47, s47, 32768
    s_and_b32 s47, s47, 131071
    ds_read_b64_tr_b16 v[200:201], v212 offset:7168
    ds_read_b64_tr_b16 v[202:203], v212 offset:7424
    s_waitcnt lgkmcnt(14)
    v_mfma_f32_32x32x16_bf16 v[140:155], v[12:15], v[172:175], 0
    buffer_load_dwordx4 v214, s[32:35], s57 offen lds
    ds_read_b64_tr_b16 v[172:173], v212 offset:8192
    ds_read_b64_tr_b16 v[174:175], v212 offset:8448
    s_waitcnt lgkmcnt(14)
    v_mfma_f32_32x32x16_bf16 v[140:155], v[16:19], v[176:179], v[140:155]
    buffer_load_dwordx4 v214, s[32:35], s53 offen offset:1024 lds
    ds_read_b64_tr_b16 v[176:177], v212 offset:9216
    ds_read_b64_tr_b16 v[178:179], v212 offset:9472
    s_waitcnt lgkmcnt(14)
    v_mfma_f32_32x32x16_bf16 v[140:155], v[20:23], v[180:183], v[140:155]
    buffer_load_dwordx4 v214, s[32:35], s54 offen offset:2048 lds
    ds_read_b64_tr_b16 v[180:181], v212 offset:10240
    ds_read_b64_tr_b16 v[182:183], v212 offset:10496
    s_waitcnt lgkmcnt(14)
    v_mfma_f32_32x32x16_bf16 v[140:155], v[24:27], v[184:187], v[140:155]
    buffer_load_dwordx4 v214, s[32:35], s55 offen offset:3072 lds
    ds_read_b64_tr_b16 v[184:185], v212 offset:11264
    ds_read_b64_tr_b16 v[186:187], v212 offset:11520
    s_waitcnt lgkmcnt(14)
    v_mfma_f32_32x32x16_bf16 v[140:155], v[28:31], v[188:191], v[140:155]
    s_lshr_b32 s60, s50, 2
    s_lshl_b32 s60, s60, 19
    s_and_b32 s61, s50, 3
    s_lshl_b32 s61, s61, 10
    s_add_u32 s60, s60, s61
    s_add_u32 s60, s60, s51
    s_add_u32 s61, s60, 4096
    s_add_u32 s50, s50, 1
    ds_read_b64_tr_b16 v[188:189], v212 offset:12288
    ds_read_b64_tr_b16 v[190:191], v212 offset:12544
    s_waitcnt lgkmcnt(14)
    v_mfma_f32_32x32x16_bf16 v[140:155], v[32:35], v[192:195], v[140:155]
    v_cvt_pk_bf16_f32 v204, v156, v157
    ds_read_b64_tr_b16 v[192:193], v212 offset:13312
    ds_read_b64_tr_b16 v[194:195], v212 offset:13568
    s_waitcnt lgkmcnt(14)
    v_mfma_f32_32x32x16_bf16 v[140:155], v[36:39], v[196:199], v[140:155]
    v_cvt_pk_bf16_f32 v205, v158, v159
    ds_read_b64_tr_b16 v[196:197], v212 offset:14336
    ds_read_b64_tr_b16 v[198:199], v212 offset:14592
    s_waitcnt lgkmcnt(14)
    v_mfma_f32_32x32x16_bf16 v[140:155], v[40:43], v[200:203], v[140:155]
    v_cvt_pk_bf16_f32 v206, v160, v161
    ds_read_b64_tr_b16 v[200:201], v212 offset:15360
    ds_read_b64_tr_b16 v[202:203], v212 offset:15616
    s_waitcnt lgkmcnt(14)
    v_mfma_f32_32x32x16_bf16 v[140:155], v[44:47], v[172:175], v[140:155]
    v_cvt_pk_bf16_f32 v207, v162, v163
    ds_read_b64_tr_b16 v[172:173], v212 offset:16384
    ds_read_b64_tr_b16 v[174:175], v212 offset:16640
    s_waitcnt lgkmcnt(14)
    v_mfma_f32_32x32x16_bf16 v[140:155], v[48:51], v[176:179], v[140:155]
    v_cvt_pk_bf16_f32 v208, v164, v165
    ds_read_b64_tr_b16 v[176:177], v212 offset:17408
    ds_read_b64_tr_b16 v[178:179], v212 offset:17664
    s_waitcnt lgkmcnt(14)
    v_mfma_f32_32x32x16_bf16 v[140:155], v[52:55], v[180:183], v[140:155]
    v_cvt_pk_bf16_f32 v209, v166, v167
    ds_read_b64_tr_b16 v[180:181], v212 offset:18432
    ds_read_b64_tr_b16 v[182:183], v212 offset:18688
    s_waitcnt lgkmcnt(14)
    v_mfma_f32_32x32x16_bf16 v[140:155], v[56:59], v[184:187], v[140:155]
    v_cvt_pk_bf16_f32 v210, v168, v169
    ds_read_b64_tr_b16 v[184:185], v212 offset:19456
    ds_read_b64_tr_b16 v[186:187], v212 offset:19712
    s_waitcnt lgkmcnt(14)
    v_mfma_f32_32x32x16_bf16 v[140:155], v[60:63], v[188:191], v[140:155]
    v_cvt_pk_bf16_f32 v211, v170, v171
    ds_read_b64_tr_b16 v[188:189], v212 offset:20480
    ds_read_b64_tr_b16 v[190:191], v212 offset:20736
    s_waitcnt lgkmcnt(14)
    v_mfma_f32_32x32x16_bf16 v[140:155], v[64:67], v[192:195], v[140:155]
    buffer_store_dwordx4 v[204:207], v215, s[36:39], s60 offen
    ds_read_b64_tr_b16 v[192:193], v212 offset:21504
    ds_read_b64_tr_b16 v[194:195], v212 offset:21760
    s_waitcnt lgkmcnt(14)
    v_mfma_f32_32x32x16_bf16 v[140:155], v[68:71], v[196:199], v[140:155]
    buffer_store_dwordx4 v[208:211], v215, s[36:39], s61 offen
    ds_read_b64_tr_b16 v[196:197], v212 offset:22528
    ds_read_b64_tr_b16 v[198:199], v212 offset:22784
    s_waitcnt lgkmcnt(14)
    v_mfma_f32_32x32x16_bf16 v[140:155], v[72:75], v[200:203], v[140:155]
    ds_read_b64_tr_b16 v[200:201], v212 offset:23552
    ds_read_b64_tr_b16 v[202:203], v212 offset:23808
    s_waitcnt lgkmcnt(14)
    v_mfma_f32_32x32x16_bf16 v[140:155], v[76:79], v[172:175], v[140:155]
    ds_read_b64_tr_b16 v[172:173], v212 offset:24576
    ds_read_b64_tr_b16 v[174:175], v212 offset:24832
    s_waitcnt lgkmcnt(14)
    v_mfma_f32_32x32x16_bf16 v[140:155], v[80:83], v[176:179], v[140:155]
    ds_read_b64_tr_b16 v[176:177], v212 offset:25600
    ds_read_b64_tr_b16 v[178:179], v212 offset:25856
    s_waitcnt lgkmcnt(14)
    v_mfma_f32_32x32x16_bf16 v[140:155], v[84:87], v[180:183], v[140:155]
    ds_read_b64_tr_b16 v[180:181], v212 offset:26624
    ds_read_b64_tr_b16 v[182:183], v212 offset:26880
    s_waitcnt lgkmcnt(14)
    v_mfma_f32_32x32x16_bf16 v[140:155], v[88:91], v[184:187], v[140:155]
    ds_read_b64_tr_b16 v[184:185], v212 offset:27648
    ds_read_b64_tr_b16 v[186:187], v212 offset:27904
    s_waitcnt lgkmcnt(14)
    v_mfma_f32_32x32x16_bf16 v[140:155], v[92:95], v[188:191], v[140:155]
    ds_read_b64_tr_b16 v[188:189], v212 offset:28672
    ds_read_b64_tr_b16 v[190:191], v212 offset:28928
    s_waitcnt lgkmcnt(14)
    v_mfma_f32_32x32x16_bf16 v[140:155], v[96:99], v[192:195], v[140:155]
    ds_read_b64_tr_b16 v[192:193], v212 offset:29696
    ds_read_b64_tr_b16 v[194:195], v212 offset:29952
    s_waitcnt lgkmcnt(14)
    v_mfma_f32_32x32x16_bf16 v[140:155], v[100:103], v[196:199], v[140:155]
    ds_read_b64_tr_b16 v[196:197], v212 offset:30720
    ds_read_b64_tr_b16 v[198:199], v212 offset:30976
    s_waitcnt lgkmcnt(14)
    v_mfma_f32_32x32x16_bf16 v[140:155], v[104:107], v[200:203], v[140:155]
    ds_read_b64_tr_b16 v[200:201], v212 offset:31744
    ds_read_b64_tr_b16 v[202:203], v212 offset:32000
    s_waitcnt lgkmcnt(14)
    v_mfma_f32_32x32x16_bf16 v[140:155], v[108:111], v[172:175], v[140:155]
    ds_read_b64_tr_b16 v[172:173], v213
    ds_read_b64_tr_b16 v[174:175], v213 offset:256
    s_waitcnt lgkmcnt(14)
    v_mfma_f32_32x32x16_bf16 v[140:155], v[112:115], v[176:179], v[140:155]
    ds_read_b64_tr_b16 v[176:177], v213 offset:1024
    ds_read_b64_tr_b16 v[178:179], v213 offset:1280
    s_waitcnt lgkmcnt(14)
    v_mfma_f32_32x32x16_bf16 v[140:155], v[116:119], v[180:183], v[140:155]
    ds_read_b64_tr_b16 v[180:181], v213 offset:2048
    ds_read_b64_tr_b16 v[182:183], v213 offset:2304
    s_waitcnt lgkmcnt(14)
    v_mfma_f32_32x32x16_bf16 v[140:155], v[120:123], v[184:187], v[140:155]
    ds_read_b64_tr_b16 v[184:185], v213 offset:3072
    ds_read_b64_tr_b16 v[186:187], v213 offset:3328
    s_waitcnt lgkmcnt(14)
    v_mfma_f32_32x32x16_bf16 v[140:155], v[124:127], v[188:191], v[140:155]
    ds_read_b64_tr_b16 v[188:189], v213 offset:4096
    ds_read_b64_tr_b16 v[190:191], v213 offset:4352
    s_waitcnt lgkmcnt(14)
    v_mfma_f32_32x32x16_bf16 v[140:155], v[128:131], v[192:195], v[140:155]
    ds_read_b64_tr_b16 v[192:193], v213 offset:5120
    ds_read_b64_tr_b16 v[194:195], v213 offset:5376
    s_waitcnt lgkmcnt(14)
    v_mfma_f32_32x32x16_bf16 v[140:155], v[132:135], v[196:199], v[140:155]
    ds_read_b64_tr_b16 v[196:197], v213 offset:6144
    ds_read_b64_tr_b16 v[198:199], v213 offset:6400
    s_waitcnt lgkmcnt(14)
    v_mfma_f32_32x32x16_bf16 v[140:155], v[136:139], v[200:203], v[140:155]
    s_add_u32 s48, s48, 32768
    s_and_b32 s48, s48, 131071
    v_add_u32 v212, s48, v7
    s_sub_u32 s49, s49, 1
    s_cmp_lg_u32 s49, 0
    s_cbranch_scc1 proj_v_loop
proj_v_endA:
    s_nop 15
    s_lshr_b32 s60, s50, 2
    s_lshl_b32 s60, s60, 19
    s_and_b32 s61, s50, 3
    s_lshl_b32 s61, s61, 10
    s_add_u32 s60, s60, s61
    s_add_u32 s60, s60, s51
    s_add_u32 s61, s60, 4096
    s_add_u32 s50, s50, 1
    v_cvt_pk_bf16_f32 v204, v140, v141
    v_cvt_pk_bf16_f32 v205, v142, v143
    v_cvt_pk_bf16_f32 v206, v144, v145
    v_cvt_pk_bf16_f32 v207, v146, v147
    v_cvt_pk_bf16_f32 v208, v148, v149
    v_cvt_pk_bf16_f32 v209, v150, v151
    v_cvt_pk_bf16_f32 v210, v152, v153
    v_cvt_pk_bf16_f32 v211, v154, v155
    buffer_store_dwordx4 v[204:207], v215, s[36:39], s60 offen
    buffer_store_dwordx4 v[208:211], v215, s[36:39], s61 offen
    s_waitcnt vmcnt(0)
    s_branch proj_end
proj_v_endB:
    s_nop 15
    s_lshr_b32 s60, s50, 2
    s_lshl_b32 s60, s60, 19
    s_and_b32 s61, s50, 3
    s_lshl_b32 s61, s61, 10
    s_add_u32 s60, s60, s61
    s_add_u32 s60, s60, s51
    s_add_u32 s61, s60, 4096
    s_add_u32 s50, s50, 1
    v_cvt_pk_bf16_f32 v204, v156, v157
    v_cvt_pk_bf16_f32 v205, v158, v159
    v_cvt_pk_bf16_f32 v206, v160, v161
    v_cvt_pk_bf16_f32 v207, v162, v163
    v_cvt_pk_bf16_f32 v208, v164, v165
    v_cvt_pk_bf16_f32 v209, v166, v167
    v_cvt_pk_bf16_f32 v210, v168, v169
    v_cvt_pk_bf16_f32 v211, v170, v171
    buffer_store_dwordx4 v[204:207], v215, s[36:39], s60 offen
    buffer_store_dwordx4 v[208:211], v215, s[36:39], s61 offen
    s_waitcnt vmcnt(0)
    s_branch proj_end
proj_type_f:
    v_lshrrev_b32 v6, 2, v2
    s_mov_b32 s21, 2752
    v_mul_lo_u32 v214, v6, s21
    v_and_b32 v6, 3, v2
    v_lshlrev_b32 v6, 4, v6
    v_add_u32 v214, v214, v6
    s_lshl_b32 s21, s19, 3
    s_add_u32 s21, s21, s18
    s_mul_i32 s21, s21, 88064
    v_lshlrev_b32 v215, 4, v2
    v_add_u32 v215, s21, v215
    s_mul_i32 s45, s18, 176128
    s_lshl_b32 s21, s25, 6
    s_add_u32 s45, s45, s21
    s_mov_b32 s46, s26
    s_mov_b32 s47, 0
    s_mov_b32 s48, 0
    s_mov_b32 s50, s25
    s_mov_b32 s51, 0x4000000
    s_cmp_lg_u32 s18, 0
    s_cbranch_scc1 proj_nb_1
    s_mov_b32 m0, 131072
    s_lshl_b32 s21, s25, 6
    v_lshlrev_b32 v6, 4, v2
    buffer_load_dwordx4 v6, s[40:43], s21 offen lds
proj_nb_1:
    v_mov_b32 v217, 0
    v_mov_b32 v221, 0
    v_mov_b32 v218, 0
    v_mov_b32 v222, 0
    v_mov_b32 v219, 0
    v_mov_b32 v223, 0
    v_cmp_gt_u32 vcc, 32, v2
    v_mov_b32 v6, 0
    v_mov_b32 v8, 0x3f80
    v_cndmask_b32 v220, v6, v8, vcc
    v_lshlrev_b32 v224, 1, v4
    v_add_u32 v224, 131072, v224
    v_mov_b32 v225, 0xc0135761
    s_mov_b32 s62, 0xbdd2d3e8
    s_cmp_gt_i32 s46, 0
    s_cselect_b32 s57, s45, s63
    s_sub_u32 s46, s46, 1
    s_add_u32 s58, s47, s59
    s_mov_b32 m0, s58
    s_add_u32 s53, s57, 43008
    s_add_u32 s54, s57, 86016
    s_add_u32 s55, s57, 129024
    s_add_u32 s45, s45, 64
    s_add_u32 s47, s47, 32768
    s_and_b32 s47, s47, 131071
    buffer_load_dwordx4 v214, s[32:35], s57 offen lds
    buffer_load_dwordx4 v214, s[32:35], s53 offen offset:1024 lds
    buffer_load_dwordx4 v214, s[32:35], s54 offen offset:2048 lds
    buffer_load_dwordx4 v214, s[32:35], s55 offen offset:3072 lds
    s_cmp_gt_i32 s46, 0
    s_cselect_b32 s57, s45, s63
    s_sub_u32 s46, s46, 1
    s_add_u32 s58, s47, s59
    s_mov_b32 m0, s58
    s_add_u32 s53, s57, 43008
    s_add_u32 s54, s57, 86016
    s_add_u32 s55, s57, 129024
    s_add_u32 s45, s45, 64
    s_add_u32 s47, s47, 32768
    s_and_b32 s47, s47, 131071
    buffer_load_dwordx4 v214, s[32:35], s57 offen lds
    buffer_load_dwordx4 v214, s[32:35], s53 offen offset:1024 lds
    buffer_load_dwordx4 v214, s[32:35], s54 offen offset:2048 lds
    buffer_load_dwordx4 v214, s[32:35], s55 offen offset:3072 lds
    s_cmp_gt_i32 s46, 0
    s_cselect_b32 s57, s45, s63
    s_sub_u32 s46, s46, 1
    s_add_u32 s58, s47, s59
    s_mov_b32 m0, s58
    s_add_u32 s53, s57, 43008
    s_add_u32 s54, s57, 86016
    s_add_u32 s55, s57, 129024
    s_add_u32 s45, s45, 64
    s_add_u32 s47, s47, 32768
    s_and_b32 s47, s47, 131071
    buffer_load_dwordx4 v214, s[32:35], s57 offen lds
    buffer_load_dwordx4 v214, s[32:35], s53 offen offset:1024 lds
    buffer_load_dwordx4 v214, s[32:35], s54 offen offset:2048 lds
    buffer_load_dwordx4 v214, s[32:35], s55 offen offset:3072 lds
    s_lshl_b32 s21, s19, 3
    s_add_u32 s21, s21, s18
    s_lshl_b32 s21, s21, 15
    s_add_u32 s21, s21, s44
    s_mov_b32 s56, s21
    buffer_load_dwordx4 v[12:15], v5, s[36:39], s56 offen
    buffer_load_dwordx4 v[16:19], v5, s[36:39], s56 offen offset:1024
    buffer_load_dwordx4 v[20:23], v5, s[36:39], s56 offen offset:2048
    buffer_load_dwordx4 v[24:27], v5, s[36:39], s56 offen offset:3072
    s_add_u32 s56, s56, 4096
    buffer_load_dwordx4 v[28:31], v5, s[36:39], s56 offen
    buffer_load_dwordx4 v[32:35], v5, s[36:39], s56 offen offset:1024
    buffer_load_dwordx4 v[36:39], v5, s[36:39], s56 offen offset:2048
    buffer_load_dwordx4 v[40:43], v5, s[36:39], s56 offen offset:3072
    s_waitcnt vmcnt(8)
    s_barrier
    v_mov_b32 v212, v7
    v_add_u32 v213, 32768, v7
    s_mov_b32 s48, 32768
    ds_read_b64_tr_b16 v[172:173], v212
    ds_read_b64_tr_b16 v[174:175], v212 offset:256
    ds_read_b64_tr_b16 v[176:177], v212 offset:1024
    ds_read_b64_tr_b16 v[178:179], v212 offset:1280
    ds_read_b64_tr_b16 v[180:181], v212 offset:2048
    ds_read_b64_tr_b16 v[182:183], v212 offset:2304
    ds_read_b64_tr_b16 v[184:185], v212 offset:3072
    ds_read_b64_tr_b16 v[186:187], v212 offset:3328
    ds_read_b64_tr_b16 v[188:189], v212 offset:4096
    ds_read_b64_tr_b16 v[190:191], v212 offset:4352
    ds_read_b64_tr_b16 v[192:193], v212 offset:5120
    ds_read_b64_tr_b16 v[194:195], v212 offset:5376
    ds_read_b64_tr_b16 v[196:197], v212 offset:6144
    ds_read_b64_tr_b16 v[198:199], v212 offset:6400
    s_cmp_gt_i32 s46, 0
    s_cselect_b32 s57, s45, s63
    s_sub_u32 s46, s46, 1
    s_add_u32 s58, s47, s59
    s_mov_b32 m0, s58
    s_add_u32 s53, s57, 43008
    s_add_u32 s54, s57, 86016
    s_add_u32 s55, s57, 129024
    s_add_u32 s45, s45, 64
    s_add_u32 s47, s47, 32768
    s_and_b32 s47, s47, 131071
    ds_read_u16 v216, v224
    v_add_u32 v224, 64, v224
    ds_read_b64_tr_b16 v[200:201], v212 offset:7168
    ds_read_b64_tr_b16 v[202:203], v212 offset:7424
    s_waitcnt lgkmcnt(15)
    s_add_u32 s56, s56, 4096
    buffer_load_dwordx4 v[44:47], v5, s[36:39], s56 offen
    s_waitcnt vmcnt(8)
    v_mfma_f32_32x32x16_bf16 v[140:155], v[172:175], v[12:15], 0
    buffer_load_dwordx4 v214, s[32:35], s57 offen lds
    ds_read_b64_tr_b16 v[172:173], v212 offset:8192
    ds_read_b64_tr_b16 v[174:175], v212 offset:8448
    s_waitcnt lgkmcnt(15)
    buffer_load_dwordx4 v[48:51], v5, s[36:39], s56 offen offset:1024
    s_waitcnt vmcnt(9)
    v_mfma_f32_32x32x16_bf16 v[140:155], v[176:179], v[16:19], v[140:155]
    buffer_load_dwordx4 v214, s[32:35], s53 offen offset:1024 lds
    ds_read_b64_tr_b16 v[176:177], v212 offset:9216
    ds_read_b64_tr_b16 v[178:179], v212 offset:9472
    s_waitcnt lgkmcnt(15)
    buffer_load_dwordx4 v[52:55], v5, s[36:39], s56 offen offset:2048
    s_waitcnt vmcnt(10)
    v_mfma_f32_32x32x16_bf16 v[140:155], v[180:183], v[20:23], v[140:155]
    buffer_load_dwordx4 v214, s[32:35], s54 offen offset:2048 lds
    ds_read_b64_tr_b16 v[180:181], v212 offset:10240
    ds_read_b64_tr_b16 v[182:183], v212 offset:10496
    s_waitcnt lgkmcnt(15)
    buffer_load_dwordx4 v[56:59], v5, s[36:39], s56 offen offset:3072
    s_waitcnt vmcnt(11)
    v_mfma_f32_32x32x16_bf16 v[140:155], v[184:187], v[24:27], v[140:155]
    buffer_load_dwordx4 v214, s[32:35], s55 offen offset:3072 lds
    ds_read_b64_tr_b16 v[184:185], v212 offset:11264
    ds_read_b64_tr_b16 v[186:187], v212 offset:11520
    s_waitcnt lgkmcnt(15)
    s_add_u32 s56, s56, 4096
    buffer_load_dwordx4 v[60:63], v5, s[36:39], s56 offen
    s_waitcnt vmcnt(12)
    v_mfma_f32_32x32x16_bf16 v[140:155], v[188:191], v[28:31], v[140:155]
    ds_read_b64_tr_b16 v[188:189], v212 offset:12288
    ds_read_b64_tr_b16 v[190:191], v212 offset:12544
    s_waitcnt lgkmcnt(15)
    buffer_load_dwordx4 v[64:67], v5, s[36:39], s56 offen offset:1024
    s_waitcnt vmcnt(12)
    v_mfma_f32_32x32x16_bf16 v[140:155], v[192:195], v[32:35], v[140:155]
    ds_read_b64_tr_b16 v[192:193], v212 offset:13312
    ds_read_b64_tr_b16 v[194:195], v212 offset:13568
    s_waitcnt lgkmcnt(15)
    buffer_load_dwordx4 v[68:71], v5, s[36:39], s56 offen offset:2048
    s_waitcnt vmcnt(12)
    v_mfma_f32_32x32x16_bf16 v[140:155], v[196:199], v[36:39], v[140:155]
    ds_read_b64_tr_b16 v[196:197], v212 offset:14336
    ds_read_b64_tr_b16 v[198:199], v212 offset:14592
    s_waitcnt lgkmcnt(14)
    buffer_load_dwordx4 v[72:75], v5, s[36:39], s56 offen offset:3072
    s_waitcnt vmcnt(12)
    v_mfma_f32_32x32x16_bf16 v[140:155], v[200:203], v[40:43], v[140:155]
    ds_read_b64_tr_b16 v[200:201], v212 offset:15360
    ds_read_b64_tr_b16 v[202:203], v212 offset:15616
    s_waitcnt lgkmcnt(14)
    s_add_u32 s56, s56, 4096
    buffer_load_dwordx4 v[76:79], v5, s[36:39], s56 offen
    s_waitcnt vmcnt(12)
    v_mfma_f32_32x32x16_bf16 v[140:155], v[172:175], v[44:47], v[140:155]
    ds_read_b64_tr_b16 v[172:173], v212 offset:16384
    ds_read_b64_tr_b16 v[174:175], v212 offset:16640
    s_waitcnt lgkmcnt(14)
    buffer_load_dwordx4 v[80:83], v5, s[36:39], s56 offen offset:1024
    s_waitcnt vmcnt(11)
    v_mfma_f32_32x32x16_bf16 v[140:155], v[176:179], v[48:51], v[140:155]
    ds_read_b64_tr_b16 v[176:177], v212 offset:17408
    ds_read_b64_tr_b16 v[178:179], v212 offset:17664
    s_waitcnt lgkmcnt(14)
    buffer_load_dwordx4 v[84:87], v5, s[36:39], s56 offen offset:2048
    s_waitcnt vmcnt(10)
    v_mfma_f32_32x32x16_bf16 v[140:155], v[180:183], v[52:55], v[140:155]
    ds_read_b64_tr_b16 v[180:181], v212 offset:18432
    ds_read_b64_tr_b16 v[182:183], v212 offset:18688
    s_waitcnt lgkmcnt(14)
    buffer_load_dwordx4 v[88:91], v5, s[36:39], s56 offen offset:3072
    s_waitcnt vmcnt(9)
    v_mfma_f32_32x32x16_bf16 v[140:155], v[184:187], v[56:59], v[140:155]
    ds_read_b64_tr_b16 v[184:185], v212 offset:19456
    ds_read_b64_tr_b16 v[186:187], v212 offset:19712
    s_waitcnt lgkmcnt(14)
    s_add_u32 s56, s56, 4096
    buffer_load_dwordx4 v[92:95], v5, s[36:39], s56 offen
    s_waitcnt vmcnt(8)
    v_mfma_f32_32x32x16_bf16 v[140:155], v[188:191], v[60:63], v[140:155]
    ds_read_b64_tr_b16 v[188:189], v212 offset:20480
    ds_read_b64_tr_b16 v[190:191], v212 offset:20736
    s_waitcnt lgkmcnt(14)
    buffer_load_dwordx4 v[96:99], v5, s[36:39], s56 offen offset:1024
    s_waitcnt vmcnt(8)
    v_mfma_f32_32x32x16_bf16 v[140:155], v[192:195], v[64:67], v[140:155]
    ds_read_b64_tr_b16 v[192:193], v212 offset:21504
    ds_read_b64_tr_b16 v[194:195], v212 offset:21760
    s_waitcnt lgkmcnt(14)
    buffer_load_dwordx4 v[100:103], v5, s[36:39], s56 offen offset:2048
    s_waitcnt vmcnt(8)
    v_mfma_f32_32x32x16_bf16 v[140:155], v[196:199], v[68:71], v[140:155]
    ds_read_b64_tr_b16 v[196:197], v212 offset:22528
    ds_read_b64_tr_b16 v[198:199], v212 offset:22784
    s_waitcnt lgkmcnt(14)
    buffer_load_dwordx4 v[104:107], v5, s[36:39], s56 offen offset:3072
    s_waitcnt vmcnt(8)
    v_mfma_f32_32x32x16_bf16 v[140:155], v[200:203], v[72:75], v[140:155]
    ds_read_b64_tr_b16 v[200:201], v212 offset:23552
    ds_read_b64_tr_b16 v[202:203], v212 offset:23808
    s_waitcnt lgkmcnt(14)
    s_add_u32 s56, s56, 4096
    buffer_load_dwordx4 v[108:111], v5, s[36:39], s56 offen
    s_waitcnt vmcnt(8)
    v_mfma_f32_32x32x16_bf16 v[140:155], v[172:175], v[76:79], v[140:155]
    ds_read_b64_tr_b16 v[172:173], v212 offset:24576
    ds_read_b64_tr_b16 v[174:175], v212 offset:24832
    s_waitcnt lgkmcnt(14)
    buffer_load_dwordx4 v[112:115], v5, s[36:39], s56 offen offset:1024
    s_waitcnt vmcnt(8)
    v_mfma_f32_32x32x16_bf16 v[140:155], v[176:179], v[80:83], v[140:155]
    ds_read_b64_tr_b16 v[176:177], v212 offset:25600
    ds_read_b64_tr_b16 v[178:179], v212 offset:25856
    s_waitcnt lgkmcnt(14)
    buffer_load_dwordx4 v[116:119], v5, s[36:39], s56 offen offset:2048
    s_waitcnt vmcnt(8)
    v_mfma_f32_32x32x16_bf16 v[140:155], v[180:183], v[84:87], v[140:155]
    ds_read_b64_tr_b16 v[180:181], v212 offset:26624
    ds_read_b64_tr_b16 v[182:183], v212 offset:26880
    s_waitcnt lgkmcnt(14)
    buffer_load_dwordx4 v[120:123], v5, s[36:39], s56 offen offset:3072
    s_waitcnt vmcnt(8)
    v_mfma_f32_32x32x16_bf16 v[140:155], v[184:187], v[88:91], v[140:155]
    ds_read_b64_tr_b16 v[184:185], v212 offset:27648
    ds_read_b64_tr_b16 v[186:187], v212 offset:27904
    s_waitcnt lgkmcnt(14)
    s_add_u32 s56, s56, 4096
    buffer_load_dwordx4 v[124:127], v5, s[36:39], s56 offen
    s_waitcnt vmcnt(8)
    v_mfma_f32_32x32x16_bf16 v[140:155], v[188:191], v[92:95], v[140:155]
    ds_read_b64_tr_b16 v[188:189], v212 offset:28672
    ds_read_b64_tr_b16 v[190:191], v212 offset:28928
    s_waitcnt lgkmcnt(14)
    buffer_load_dwordx4 v[128:131], v5, s[36:39], s56 offen offset:1024
    s_waitcnt vmcnt(8)
    v_mfma_f32_32x32x16_bf16 v[140:155], v[192:195], v[96:99], v[140:155]
    ds_read_b64_tr_b16 v[192:193], v212 offset:29696
    ds_read_b64_tr_b16 v[194:195], v212 offset:29952
    s_waitcnt lgkmcnt(14)
    buffer_load_dwordx4 v[132:135], v5, s[36:39], s56 offen offset:2048
    s_waitcnt vmcnt(8)
    v_mfma_f32_32x32x16_bf16 v[140:155], v[196:199], v[100:103], v[140:155]
    ds_read_b64_tr_b16 v[196:197], v212 offset:30720
    ds_read_b64_tr_b16 v[198:199], v212 offset:30976
    s_waitcnt lgkmcnt(14)
    buffer_load_dwordx4 v[136:139], v5, s[36:39], s56 offen offset:3072
    s_waitcnt vmcnt(8)
    v_mfma_f32_32x32x16_bf16 v[140:155], v[200:203], v[104:107], v[140:155]
    ds_read_b64_tr_b16 v[200:201], v212 offset:31744
    ds_read_b64_tr_b16 v[202:203], v212 offset:32000
    s_waitcnt lgkmcnt(14)
    s_waitcnt vmcnt(7)
    v_mfma_f32_32x32x16_bf16 v[140:155], v[172:175], v[108:111], v[140:155]
    ds_read_b64_tr_b16 v[172:173], v213
    ds_read_b64_tr_b16 v[174:175], v213 offset:256
    s_waitcnt lgkmcnt(14)
    s_waitcnt vmcnt(6)
    v_mfma_f32_32x32x16_bf16 v[140:155], v[176:179], v[112:115], v[140:155]
    ds_read_b64_tr_b16 v[176:177], v213 offset:1024
    ds_read_b64_tr_b16 v[178:179], v213 offset:1280
    s_waitcnt lgkmcnt(14)
    s_waitcnt vmcnt(5)
    v_mfma_f32_32x32x16_bf16 v[140:155], v[180:183], v[116:119], v[140:155]
    ds_read_b64_tr_b16 v[180:181], v213 offset:2048
    ds_read_b64_tr_b16 v[182:183], v213 offset:2304
    s_waitcnt lgkmcnt(14)
    s_waitcnt vmcnt(4)
    v_mfma_f32_32x32x16_bf16 v[140:155], v[184:187], v[120:123], v[140:155]
    ds_read_b64_tr_b16 v[184:185], v213 offset:3072
    ds_read_b64_tr_b16 v[186:187], v213 offset:3328
    s_waitcnt lgkmcnt(14)
    s_waitcnt vmcnt(3)
    v_mfma_f32_32x32x16_bf16 v[140:155], v[188:191], v[124:127], v[140:155]
    ds_read_b64_tr_b16 v[188:189], v213 offset:4096
    ds_read_b64_tr_b16 v[190:191], v213 offset:4352
    s_waitcnt lgkmcnt(14)
    s_waitcnt vmcnt(2)
    v_mfma_f32_32x32x16_bf16 v[140:155], v[192:195], v[128:131], v[140:155]
    ds_read_b64_tr_b16 v[192:193], v213 offset:5120
    ds_read_b64_tr_b16 v[194:195], v213 offset:5376
    s_waitcnt lgkmcnt(14)
    s_waitcnt vmcnt(1)
    v_mfma_f32_32x32x16_bf16 v[140:155], v[196:199], v[132:135], v[140:155]
    ds_read_b64_tr_b16 v[196:197], v213 offset:6144
    ds_read_b64_tr_b16 v[198:199], v213 offset:6400
    s_waitcnt lgkmcnt(14)
    s_waitcnt vmcnt(0)
    v_mfma_f32_32x32x16_bf16 v[140:155], v[200:203], v[136:139], v[140:155]
    v_mfma_f32_32x32x16_bf16 v[140:155], v[216:219], v[220:223], v[140:155]
    s_add_u32 s48, s48, 32768
    s_and_b32 s48, s48, 131071
    v_add_u32 v212, s48, v7
    s_sub_u32 s49, s26, 1
proj_f_loop:
    s_waitcnt vmcnt(6)
    s_barrier
    s_cmp_gt_i32 s46, 0
    s_cselect_b32 s57, s45, s63
    s_sub_u32 s46, s46, 1
    s_add_u32 s58, s47, s59
    s_mov_b32 m0, s58
    s_add_u32 s53, s57, 43008
    s_add_u32 s54, s57, 86016
    s_add_u32 s55, s57, 129024
    s_add_u32 s45, s45, 64
    s_add_u32 s47, s47, 32768
    s_and_b32 s47, s47, 131071
    ds_read_u16 v216, v224
    v_add_u32 v224, 64, v224
    ds_read_b64_tr_b16 v[200:201], v213 offset:7168
    ds_read_b64_tr_b16 v[202:203], v213 offset:7424
    s_waitcnt lgkmcnt(15)
    v_mfma_f32_32x32x16_bf16 v[156:171], v[172:175], v[12:15], 0
    buffer_load_dwordx4 v214, s[32:35], s57 offen lds
    ds_read_b64_tr_b16 v[172:173], v213 offset:8192
    ds_read_b64_tr_b16 v[174:175], v213 offset:8448
    s_waitcnt lgkmcnt(15)
    v_mfma_f32_32x32x16_bf16 v[156:171], v[176:179], v[16:19], v[156:171]
    buffer_load_dwordx4 v214, s[32:35], s53 offen offset:1024 lds
    ds_read_b64_tr_b16 v[176:177], v213 offset:9216
    ds_read_b64_tr_b16 v[178:179], v213 offset:9472
    s_waitcnt lgkmcnt(15)
    v_mfma_f32_32x32x16_bf16 v[156:171], v[180:183], v[20:23], v[156:171]
    buffer_load_dwordx4 v214, s[32:35], s54 offen offset:2048 lds
    ds_read_b64_tr_b16 v[180:181], v213 offset:10240
    ds_read_b64_tr_b16 v[182:183], v213 offset:10496
    s_waitcnt lgkmcnt(15)
    v_mfma_f32_32x32x16_bf16 v[156:171], v[184:187], v[24:27], v[156:171]
    buffer_load_dwordx4 v214, s[32:35], s55 offen offset:3072 lds
    ds_read_b64_tr_b16 v[184:185], v213 offset:11264
    ds_read_b64_tr_b16 v[186:187], v213 offset:11520
    s_waitcnt lgkmcnt(15)
    v_mfma_f32_32x32x16_bf16 v[156:171], v[188:191], v[28:31], v[156:171]
    s_lshl_b32 s60, s50, 11
    s_add_u32 s60, s60, s51
    s_add_u32 s50, s50, 1
    v_mul_f32 v226, v140, v140
    v_mul_f32 v227, v141, v141
    v_mul_f32 v228, v142, v142
    v_mul_f32 v229, v143, v143
    ds_read_b64_tr_b16 v[188:189], v213 offset:12288
    ds_read_b64_tr_b16 v[190:191], v213 offset:12544
    s_waitcnt lgkmcnt(15)
    v_mfma_f32_32x32x16_bf16 v[156:171], v[192:195], v[32:35], v[156:171]
    v_fma_f32 v226, v226, s62, v225
    v_fma_f32 v227, v227, s62, v225
    v_fma_f32 v228, v228, s62, v225
    v_fma_f32 v229, v229, s62, v225
    v_mul_f32 v226, v226, v140
    v_mul_f32 v227, v227, v141
    v_mul_f32 v228, v228, v142
    v_mul_f32 v229, v229, v143
    ds_read_b64_tr_b16 v[192:193], v213 offset:13312
    ds_read_b64_tr_b16 v[194:195], v213 offset:13568
    s_waitcnt lgkmcnt(15)
    v_mfma_f32_32x32x16_bf16 v[156:171], v[196:199], v[36:39], v[156:171]
    v_exp_f32 v226, v226
    v_exp_f32 v227, v227
    v_exp_f32 v228, v228
    v_exp_f32 v229, v229
    v_add_f32 v226, 1.0, v226
    v_add_f32 v227, 1.0, v227
    v_add_f32 v228, 1.0, v228
    v_add_f32 v229, 1.0, v229
    ds_read_b64_tr_b16 v[196:197], v213 offset:14336
    ds_read_b64_tr_b16 v[198:199], v213 offset:14592
    s_waitcnt lgkmcnt(14)
    v_mfma_f32_32x32x16_bf16 v[156:171], v[200:203], v[40:43], v[156:171]
    v_rcp_f32 v226, v226
    v_rcp_f32 v227, v227
    v_rcp_f32 v228, v228
    v_rcp_f32 v229, v229
    v_mul_f32 v140, v140, v226
    v_mul_f32 v141, v141, v227
    v_mul_f32 v142, v142, v228
    v_mul_f32 v143, v143, v229
    ds_read_b64_tr_b16 v[200:201], v213 offset:15360
    ds_read_b64_tr_b16 v[202:203], v213 offset:15616
    s_waitcnt lgkmcnt(14)
    v_mfma_f32_32x32x16_bf16 v[156:171], v[172:175], v[44:47], v[156:171]
    v_mul_f32 v226, v144, v144
    v_mul_f32 v227, v145, v145
    v_mul_f32 v228, v146, v146
    v_mul_f32 v229, v147, v147
    v_fma_f32 v226, v226, s62, v225
    v_fma_f32 v227, v227, s62, v225
    v_fma_f32 v228, v228, s62, v225
    v_fma_f32 v229, v229, s62, v225
    ds_read_b64_tr_b16 v[172:173], v213 offset:16384
    ds_read_b64_tr_b16 v[174:175], v213 offset:16640
    s_waitcnt lgkmcnt(14)
    v_mfma_f32_32x32x16_bf16 v[156:171], v[176:179], v[48:51], v[156:171]
    v_mul_f32 v226, v226, v144
    v_mul_f32 v227, v227, v145
    v_mul_f32 v228, v228, v146
    v_mul_f32 v229, v229, v147
    v_exp_f32 v226, v226
    v_exp_f32 v227, v227
    v_exp_f32 v228, v228
    v_exp_f32 v229, v229
    ds_read_b64_tr_b16 v[176:177], v213 offset:17408
    ds_read_b64_tr_b16 v[178:179], v213 offset:17664
    s_waitcnt lgkmcnt(14)
    v_mfma_f32_32x32x16_bf16 v[156:171], v[180:183], v[52:55], v[156:171]
    v_add_f32 v226, 1.0, v226
    v_add_f32 v227, 1.0, v227
    v_add_f32 v228, 1.0, v228
    v_add_f32 v229, 1.0, v229
    v_rcp_f32 v226, v226
    v_rcp_f32 v227, v227
    v_rcp_f32 v228, v228
    v_rcp_f32 v229, v229
    ds_read_b64_tr_b16 v[180:181], v213 offset:18432
    ds_read_b64_tr_b16 v[182:183], v213 offset:18688
    s_waitcnt lgkmcnt(14)
    v_mfma_f32_32x32x16_bf16 v[156:171], v[184:187], v[56:59], v[156:171]
    v_mul_f32 v144, v144, v226
    v_mul_f32 v145, v145, v227
    v_mul_f32 v146, v146, v228
    v_mul_f32 v147, v147, v229
    v_mul_f32 v226, v148, v148
    v_mul_f32 v227, v149, v149
    v_mul_f32 v228, v150, v150
    v_mul_f32 v229, v151, v151
    ds_read_b64_tr_b16 v[184:185], v213 offset:19456
    ds_read_b64_tr_b16 v[186:187], v213 offset:19712
    s_waitcnt lgkmcnt(14)
    v_mfma_f32_32x32x16_bf16 v[156:171], v[188:191], v[60:63], v[156:171]
    v_fma_f32 v226, v226, s62, v225
    v_fma_f32 v227, v227, s62, v225
    v_fma_f32 v228, v228, s62, v225
    v_fma_f32 v229, v229, s62, v225
    v_mul_f32 v226, v226, v148
    v_mul_f32 v227, v227, v149
    v_mul_f32 v228, v228, v150
    v_mul_f32 v229, v229, v151
    ds_read_b64_tr_b16 v[188:189], v213 offset:20480
    ds_read_b64_tr_b16 v[190:191], v213 offset:20736
    s_waitcnt lgkmcnt(14)
    v_mfma_f32_32x32x16_bf16 v[156:171], v[192:195], v[64:67], v[156:171]
    v_exp_f32 v226, v226
    v_exp_f32 v227, v227
    v_exp_f32 v228, v228
    v_exp_f32 v229, v229
    v_add_f32 v226, 1.0, v226
    v_add_f32 v227, 1.0, v227
    v_add_f32 v228, 1.0, v228
    v_add_f32 v229, 1.0, v229
    ds_read_b64_tr_b16 v[192:193], v213 offset:21504
    ds_read_b64_tr_b16 v[194:195], v213 offset:21760
    s_waitcnt lgkmcnt(14)
    v_mfma_f32_32x32x16_bf16 v[156:171], v[196:199], v[68:71], v[156:171]
    v_rcp_f32 v226, v226
    v_rcp_f32 v227, v227
    v_rcp_f32 v228, v228
    v_rcp_f32 v229, v229
    v_mul_f32 v148, v148, v226
    v_mul_f32 v149, v149, v227
    v_mul_f32 v150, v150, v228
    v_mul_f32 v151, v151, v229
    ds_read_b64_tr_b16 v[196:197], v213 offset:22528
    ds_read_b64_tr_b16 v[198:199], v213 offset:22784
    s_waitcnt lgkmcnt(14)
    v_mfma_f32_32x32x16_bf16 v[156:171], v[200:203], v[72:75], v[156:171]
    v_mul_f32 v226, v152, v152
    v_mul_f32 v227, v153, v153
    v_mul_f32 v228, v154, v154
    v_mul_f32 v229, v155, v155
    v_fma_f32 v226, v226, s62, v225
    v_fma_f32 v227, v227, s62, v225
    v_fma_f32 v228, v228, s62, v225
    v_fma_f32 v229, v229, s62, v225
    ds_read_b64_tr_b16 v[200:201], v213 offset:23552
    ds_read_b64_tr_b16 v[202:203], v213 offset:23808
    s_waitcnt lgkmcnt(14)
    v_mfma_f32_32x32x16_bf16 v[156:171], v[172:175], v[76:79], v[156:171]
    v_mul_f32 v226, v226, v152
    v_mul_f32 v227, v227, v153
    v_mul_f32 v228, v228, v154
    v_mul_f32 v229, v229, v155
    v_exp_f32 v226, v226
    v_exp_f32 v227, v227
    v_exp_f32 v228, v228
    v_exp_f32 v229, v229
    ds_read_b64_tr_b16 v[172:173], v213 offset:24576
    ds_read_b64_tr_b16 v[174:175], v213 offset:24832
    s_waitcnt lgkmcnt(14)
    v_mfma_f32_32x32x16_bf16 v[156:171], v[176:179], v[80:83], v[156:171]
    v_add_f32 v226, 1.0, v226
    v_add_f32 v227, 1.0, v227
    v_add_f32 v228, 1.0, v228
    v_add_f32 v229, 1.0, v229
    v_rcp_f32 v226, v226
    v_rcp_f32 v227, v227
    v_rcp_f32 v228, v228
    v_rcp_f32 v229, v229
    ds_read_b64_tr_b16 v[176:177], v213 offset:25600
    ds_read_b64_tr_b16 v[178:179], v213 offset:25856
    s_waitcnt lgkmcnt(14)
    v_mfma_f32_32x32x16_bf16 v[156:171], v[180:183], v[84:87], v[156:171]
    v_mul_f32 v152, v152, v226
    v_mul_f32 v153, v153, v227
    v_mul_f32 v154, v154, v228
    v_mul_f32 v155, v155, v229
    v_cvt_pk_bf16_f32 v204, v140, v141
    ds_read_b64_tr_b16 v[180:181], v213 offset:26624
    ds_read_b64_tr_b16 v[182:183], v213 offset:26880
    s_waitcnt lgkmcnt(14)
    v_mfma_f32_32x32x16_bf16 v[156:171], v[184:187], v[88:91], v[156:171]
    v_cvt_pk_bf16_f32 v205, v142, v143
    v_cvt_pk_bf16_f32 v206, v144, v145
    ds_read_b64_tr_b16 v[184:185], v213 offset:27648
    ds_read_b64_tr_b16 v[186:187], v213 offset:27904
    s_waitcnt lgkmcnt(14)
    v_mfma_f32_32x32x16_bf16 v[156:171], v[188:191], v[92:95], v[156:171]
    v_cvt_pk_bf16_f32 v207, v146, v147
    v_cvt_pk_bf16_f32 v208, v148, v149
    ds_read_b64_tr_b16 v[188:189], v213 offset:28672
    ds_read_b64_tr_b16 v[190:191], v213 offset:28928
    s_waitcnt lgkmcnt(14)
    v_mfma_f32_32x32x16_bf16 v[156:171], v[192:195], v[96:99], v[156:171]
    v_cvt_pk_bf16_f32 v209, v150, v151
    v_cvt_pk_bf16_f32 v210, v152, v153
    ds_read_b64_tr_b16 v[192:193], v213 offset:29696
    ds_read_b64_tr_b16 v[194:195], v213 offset:29952
    s_waitcnt lgkmcnt(14)
    v_mfma_f32_32x32x16_bf16 v[156:171], v[196:199], v[100:103], v[156:171]
    v_cvt_pk_bf16_f32 v211, v154, v155
    buffer_store_dwordx4 v[204:207], v215, s[36:39], s60 offen
    ds_read_b64_tr_b16 v[196:197], v213 offset:30720
    ds_read_b64_tr_b16 v[198:199], v213 offset:30976
    s_waitcnt lgkmcnt(14)
    v_mfma_f32_32x32x16_bf16 v[156:171], v[200:203], v[104:107], v[156:171]
    buffer_store_dwordx4 v[208:211], v215, s[36:39], s60 offen offset:1024
    ds_read_b64_tr_b16 v[200:201], v213 offset:31744
    ds_read_b64_tr_b16 v[202:203], v213 offset:32000
    s_waitcnt lgkmcnt(14)
    v_mfma_f32_32x32x16_bf16 v[156:171], v[172:175], v[108:111], v[156:171]
    ds_read_b64_tr_b16 v[172:173], v212
    ds_read_b64_tr_b16 v[174:175], v212 offset:256
    s_waitcnt lgkmcnt(14)
    v_mfma_f32_32x32x16_bf16 v[156:171], v[176:179], v[112:115], v[156:171]
    ds_read_b64_tr_b16 v[176:177], v212 offset:1024
    ds_read_b64_tr_b16 v[178:179], v212 offset:1280
    s_waitcnt lgkmcnt(14)
    v_mfma_f32_32x32x16_bf16 v[156:171], v[180:183], v[116:119], v[156:171]
    ds_read_b64_tr_b16 v[180:181], v212 offset:2048
    ds_read_b64_tr_b16 v[182:183], v212 offset:2304
    s_waitcnt lgkmcnt(14)
    v_mfma_f32_32x32x16_bf16 v[156:171], v[184:187], v[120:123], v[156:171]
    ds_read_b64_tr_b16 v[184:185], v212 offset:3072
    ds_read_b64_tr_b16 v[186:187], v212 offset:3328
    s_waitcnt lgkmcnt(14)
    v_mfma_f32_32x32x16_bf16 v[156:171], v[188:191], v[124:127], v[156:171]
    ds_read_b64_tr_b16 v[188:189], v212 offset:4096
    ds_read_b64_tr_b16 v[190:191], v212 offset:4352
    s_waitcnt lgkmcnt(14)
    v_mfma_f32_32x32x16_bf16 v[156:171], v[192:195], v[128:131], v[156:171]
    ds_read_b64_tr_b16 v[192:193], v212 offset:5120
    ds_read_b64_tr_b16 v[194:195], v212 offset:5376
    s_waitcnt lgkmcnt(14)
    v_mfma_f32_32x32x16_bf16 v[156:171], v[196:199], v[132:135], v[156:171]
    ds_read_b64_tr_b16 v[196:197], v212 offset:6144
    ds_read_b64_tr_b16 v[198:199], v212 offset:6400
    s_waitcnt lgkmcnt(14)
    v_mfma_f32_32x32x16_bf16 v[156:171], v[200:203], v[136:139], v[156:171]
    v_mfma_f32_32x32x16_bf16 v[156:171], v[216:219], v[220:223], v[156:171]
    s_add_u32 s48, s48, 32768
    s_and_b32 s48, s48, 131071
    v_add_u32 v213, s48, v7
    s_sub_u32 s49, s49, 1
    s_cmp_eq_u32 s49, 0
    s_cbranch_scc1 proj_f_endB
    s_waitcnt vmcnt(6)
    s_barrier
    s_cmp_gt_i32 s46, 0
    s_cselect_b32 s57, s45, s63
    s_sub_u32 s46, s46, 1
    s_add_u32 s58, s47, s59
    s_mov_b32 m0, s58
    s_add_u32 s53, s57, 43008
    s_add_u32 s54, s57, 86016
    s_add_u32 s55, s57, 129024
    s_add_u32 s45, s45, 64
    s_add_u32 s47, s47, 32768
    s_and_b32 s47, s47, 131071
    ds_read_u16 v216, v224
    v_add_u32 v224, 64, v224
    ds_read_b64_tr_b16 v[200:201], v212 offset:7168
    ds_read_b64_tr_b16 v[202:203], v212 offset:7424
    s_waitcnt lgkmcnt(15)
    v_mfma_f32_32x32x16_bf16 v[140:155], v[172:175], v[12:15], 0
    buffer_load_dwordx4 v214, s[32:35], s57 offen lds
    ds_read_b64_tr_b16 v[172:173], v212 offset:8192
    ds_read_b64_tr_b16 v[174:175], v212 offset:8448
    s_waitcnt lgkmcnt(15)
    v_mfma_f32_32x32x16_bf16 v[140:155], v[176:179], v[16:19], v[140:155]
    buffer_load_dwordx4 v214, s[32:35], s53 offen offset:1024 lds
    ds_read_b64_tr_b16 v[176:177], v212 offset:9216
    ds_read_b64_tr_b16 v[178:179], v212 offset:9472
    s_waitcnt lgkmcnt(15)
    v_mfma_f32_32x32x16_bf16 v[140:155], v[180:183], v[20:23], v[140:155]
    buffer_load_dwordx4 v214, s[32:35], s54 offen offset:2048 lds
    ds_read_b64_tr_b16 v[180:181], v212 offset:10240
    ds_read_b64_tr_b16 v[182:183], v212 offset:10496
    s_waitcnt lgkmcnt(15)
    v_mfma_f32_32x32x16_bf16 v[140:155], v[184:187], v[24:27], v[140:155]
    buffer_load_dwordx4 v214, s[32:35], s55 offen offset:3072 lds
    ds_read_b64_tr_b16 v[184:185], v212 offset:11264
    ds_read_b64_tr_b16 v[186:187], v212 offset:11520
    s_waitcnt lgkmcnt(15)
    v_mfma_f32_32x32x16_bf16 v[140:155], v[188:191], v[28:31], v[140:155]
    s_lshl_b32 s60, s50, 11
    s_add_u32 s60, s60, s51
    s_add_u32 s50, s50, 1
    v_mul_f32 v226, v156, v156
    v_mul_f32 v227, v157, v157
    v_mul_f32 v228, v158, v158
    v_mul_f32 v229, v159, v159
    ds_read_b64_tr_b16 v[188:189], v212 offset:12288
    ds_read_b64_tr_b16 v[190:191], v212 offset:12544
    s_waitcnt lgkmcnt(15)
    v_mfma_f32_32x32x16_bf16 v[140:155], v[192:195], v[32:35], v[140:155]
    v_fma_f32 v226, v226, s62, v225
    v_fma_f32 v227, v227, s62, v225
    v_fma_f32 v228, v228, s62, v225
    v_fma_f32 v229, v229, s62, v225
    v_mul_f32 v226, v226, v156
    v_mul_f32 v227, v227, v157
    v_mul_f32 v228, v228, v158
    v_mul_f32 v229, v229, v159
    ds_read_b64_tr_b16 v[192:193], v212 offset:13312
    ds_read_b64_tr_b16 v[194:195], v212 offset:13568
    s_waitcnt lgkmcnt(15)
    v_mfma_f32_32x32x16_bf16 v[140:155], v[196:199], v[36:39], v[140:155]
    v_exp_f32 v226, v226
    v_exp_f32 v227, v227
    v_exp_f32 v228, v228
    v_exp_f32 v229, v229
    v_add_f32 v226, 1.0, v226
    v_add_f32 v227, 1.0, v227
    v_add_f32 v228, 1.0, v228
    v_add_f32 v229, 1.0, v229
    ds_read_b64_tr_b16 v[196:197], v212 offset:14336
    ds_read_b64_tr_b16 v[198:199], v212 offset:14592
    s_waitcnt lgkmcnt(14)
    v_mfma_f32_32x32x16_bf16 v[140:155], v[200:203], v[40:43], v[140:155]
    v_rcp_f32 v226, v226
    v_rcp_f32 v227, v227
    v_rcp_f32 v228, v228
    v_rcp_f32 v229, v229
    v_mul_f32 v156, v156, v226
    v_mul_f32 v157, v157, v227
    v_mul_f32 v158, v158, v228
    v_mul_f32 v159, v159, v229
    ds_read_b64_tr_b16 v[200:201], v212 offset:15360
    ds_read_b64_tr_b16 v[202:203], v212 offset:15616
    s_waitcnt lgkmcnt(14)
    v_mfma_f32_32x32x16_bf16 v[140:155], v[172:175], v[44:47], v[140:155]
    v_mul_f32 v226, v160, v160
    v_mul_f32 v227, v161, v161
    v_mul_f32 v228, v162, v162
    v_mul_f32 v229, v163, v163
    v_fma_f32 v226, v226, s62, v225
    v_fma_f32 v227, v227, s62, v225
    v_fma_f32 v228, v228, s62, v225
    v_fma_f32 v229, v229, s62, v225
    ds_read_b64_tr_b16 v[172:173], v212 offset:16384
    ds_read_b64_tr_b16 v[174:175], v212 offset:16640
    s_waitcnt lgkmcnt(14)
    v_mfma_f32_32x32x16_bf16 v[140:155], v[176:179], v[48:51], v[140:155]
    v_mul_f32 v226, v226, v160
    v_mul_f32 v227, v227, v161
    v_mul_f32 v228, v228, v162
    v_mul_f32 v229, v229, v163
    v_exp_f32 v226, v226
    v_exp_f32 v227, v227
    v_exp_f32 v228, v228
    v_exp_f32 v229, v229
    ds_read_b64_tr_b16 v[176:177], v212 offset:17408
    ds_read_b64_tr_b16 v[178:179], v212 offset:17664
    s_waitcnt lgkmcnt(14)
    v_mfma_f32_32x32x16_bf16 v[140:155], v[180:183], v[52:55], v[140:155]
    v_add_f32 v226, 1.0, v226
    v_add_f32 v227, 1.0, v227
    v_add_f32 v228, 1.0, v228
    v_add_f32 v229, 1.0, v229
    v_rcp_f32 v226, v226
    v_rcp_f32 v227, v227
    v_rcp_f32 v228, v228
    v_rcp_f32 v229, v229
    ds_read_b64_tr_b16 v[180:181], v212 offset:18432
    ds_read_b64_tr_b16 v[182:183], v212 offset:18688
    s_waitcnt lgkmcnt(14)
    v_mfma_f32_32x32x16_bf16 v[140:155], v[184:187], v[56:59], v[140:155]
    v_mul_f32 v160, v160, v226
    v_mul_f32 v161, v161, v227
    v_mul_f32 v162, v162, v228
    v_mul_f32 v163, v163, v229
    v_mul_f32 v226, v164, v164
    v_mul_f32 v227, v165, v165
    v_mul_f32 v228, v166, v166
    v_mul_f32 v229, v167, v167
    ds_read_b64_tr_b16 v[184:185], v212 offset:19456
    ds_read_b64_tr_b16 v[186:187], v212 offset:19712
    s_waitcnt lgkmcnt(14)
    v_mfma_f32_32x32x16_bf16 v[140:155], v[188:191], v[60:63], v[140:155]
    v_fma_f32 v226, v226, s62, v225
    v_fma_f32 v227, v227, s62, v225
    v_fma_f32 v228, v228, s62, v225
    v_fma_f32 v229, v229, s62, v225
    v_mul_f32 v226, v226, v164
    v_mul_f32 v227, v227, v165
    v_mul_f32 v228, v228, v166
    v_mul_f32 v229, v229, v167
    ds_read_b64_tr_b16 v[188:189], v212 offset:20480
    ds_read_b64_tr_b16 v[190:191], v212 offset:20736
    s_waitcnt lgkmcnt(14)
    v_mfma_f32_32x32x16_bf16 v[140:155], v[192:195], v[64:67], v[140:155]
    v_exp_f32 v226, v226
    v_exp_f32 v227, v227
    v_exp_f32 v228, v228
    v_exp_f32 v229, v229
    v_add_f32 v226, 1.0, v226
    v_add_f32 v227, 1.0, v227
    v_add_f32 v228, 1.0, v228
    v_add_f32 v229, 1.0, v229
    ds_read_b64_tr_b16 v[192:193], v212 offset:21504
    ds_read_b64_tr_b16 v[194:195], v212 offset:21760
    s_waitcnt lgkmcnt(14)
    v_mfma_f32_32x32x16_bf16 v[140:155], v[196:199], v[68:71], v[140:155]
    v_rcp_f32 v226, v226
    v_rcp_f32 v227, v227
    v_rcp_f32 v228, v228
    v_rcp_f32 v229, v229
    v_mul_f32 v164, v164, v226
    v_mul_f32 v165, v165, v227
    v_mul_f32 v166, v166, v228
    v_mul_f32 v167, v167, v229
    ds_read_b64_tr_b16 v[196:197], v212 offset:22528
    ds_read_b64_tr_b16 v[198:199], v212 offset:22784
    s_waitcnt lgkmcnt(14)
    v_mfma_f32_32x32x16_bf16 v[140:155], v[200:203], v[72:75], v[140:155]
    v_mul_f32 v226, v168, v168
    v_mul_f32 v227, v169, v169
    v_mul_f32 v228, v170, v170
    v_mul_f32 v229, v171, v171
    v_fma_f32 v226, v226, s62, v225
    v_fma_f32 v227, v227, s62, v225
    v_fma_f32 v228, v228, s62, v225
    v_fma_f32 v229, v229, s62, v225
    ds_read_b64_tr_b16 v[200:201], v212 offset:23552
    ds_read_b64_tr_b16 v[202:203], v212 offset:23808
    s_waitcnt lgkmcnt(14)
    v_mfma_f32_32x32x16_bf16 v[140:155], v[172:175], v[76:79], v[140:155]
    v_mul_f32 v226, v226, v168
    v_mul_f32 v227, v227, v169
    v_mul_f32 v228, v228, v170
    v_mul_f32 v229, v229, v171
    v_exp_f32 v226, v226
    v_exp_f32 v227, v227
    v_exp_f32 v228, v228
    v_exp_f32 v229, v229
    ds_read_b64_tr_b16 v[172:173], v212 offset:24576
    ds_read_b64_tr_b16 v[174:175], v212 offset:24832
    s_waitcnt lgkmcnt(14)
    v_mfma_f32_32x32x16_bf16 v[140:155], v[176:179], v[80:83], v[140:155]
    v_add_f32 v226, 1.0, v226
    v_add_f32 v227, 1.0, v227
    v_add_f32 v228, 1.0, v228
    v_add_f32 v229, 1.0, v229
    v_rcp_f32 v226, v226
    v_rcp_f32 v227, v227
    v_rcp_f32 v228, v228
    v_rcp_f32 v229, v229
    ds_read_b64_tr_b16 v[176:177], v212 offset:25600
    ds_read_b64_tr_b16 v[178:179], v212 offset:25856
    s_waitcnt lgkmcnt(14)
    v_mfma_f32_32x32x16_bf16 v[140:155], v[180:183], v[84:87], v[140:155]
    v_mul_f32 v168, v168, v226
    v_mul_f32 v169, v169, v227
    v_mul_f32 v170, v170, v228
    v_mul_f32 v171, v171, v229
    v_cvt_pk_bf16_f32 v204, v156, v157
    ds_read_b64_tr_b16 v[180:181], v212 offset:26624
    ds_read_b64_tr_b16 v[182:183], v212 offset:26880
    s_waitcnt lgkmcnt(14)
    v_mfma_f32_32x32x16_bf16 v[140:155], v[184:187], v[88:91], v[140:155]
    v_cvt_pk_bf16_f32 v205, v158, v159
    v_cvt_pk_bf16_f32 v206, v160, v161
    ds_read_b64_tr_b16 v[184:185], v212 offset:27648
    ds_read_b64_tr_b16 v[186:187], v212 offset:27904
    s_waitcnt lgkmcnt(14)
    v_mfma_f32_32x32x16_bf16 v[140:155], v[188:191], v[92:95], v[140:155]
    v_cvt_pk_bf16_f32 v207, v162, v163
    v_cvt_pk_bf16_f32 v208, v164, v165
    ds_read_b64_tr_b16 v[188:189], v212 offset:28672
    ds_read_b64_tr_b16 v[190:191], v212 offset:28928
    s_waitcnt lgkmcnt(14)
    v_mfma_f32_32x32x16_bf16 v[140:155], v[192:195], v[96:99], v[140:155]
    v_cvt_pk_bf16_f32 v209, v166, v167
    v_cvt_pk_bf16_f32 v210, v168, v169
    ds_read_b64_tr_b16 v[192:193], v212 offset:29696
    ds_read_b64_tr_b16 v[194:195], v212 offset:29952
    s_waitcnt lgkmcnt(14)
    v_mfma_f32_32x32x16_bf16 v[140:155], v[196:199], v[100:103], v[140:155]
    v_cvt_pk_bf16_f32 v211, v170, v171
    buffer_store_dwordx4 v[204:207], v215, s[36:39], s60 offen
    ds_read_b64_tr_b16 v[196:197], v212 offset:30720
    ds_read_b64_tr_b16 v[198:199], v212 offset:30976
    s_waitcnt lgkmcnt(14)
    v_mfma_f32_32x32x16_bf16 v[140:155], v[200:203], v[104:107], v[140:155]
    buffer_store_dwordx4 v[208:211], v215, s[36:39], s60 offen offset:1024
    ds_read_b64_tr_b16 v[200:201], v212 offset:31744
    ds_read_b64_tr_b16 v[202:203], v212 offset:32000
    s_waitcnt lgkmcnt(14)
    v_mfma_f32_32x32x16_bf16 v[140:155], v[172:175], v[108:111], v[140:155]
    ds_read_b64_tr_b16 v[172:173], v213
    ds_read_b64_tr_b16 v[174:175], v213 offset:256
    s_waitcnt lgkmcnt(14)
    v_mfma_f32_32x32x16_bf16 v[140:155], v[176:179], v[112:115], v[140:155]
    ds_read_b64_tr_b16 v[176:177], v213 offset:1024
    ds_read_b64_tr_b16 v[178:179], v213 offset:1280
    s_waitcnt lgkmcnt(14)
    v_mfma_f32_32x32x16_bf16 v[140:155], v[180:183], v[116:119], v[140:155]
    ds_read_b64_tr_b16 v[180:181], v213 offset:2048
    ds_read_b64_tr_b16 v[182:183], v213 offset:2304
    s_waitcnt lgkmcnt(14)
    v_mfma_f32_32x32x16_bf16 v[140:155], v[184:187], v[120:123], v[140:155]
    ds_read_b64_tr_b16 v[184:185], v213 offset:3072
    ds_read_b64_tr_b16 v[186:187], v213 offset:3328
    s_waitcnt lgkmcnt(14)
    v_mfma_f32_32x32x16_bf16 v[140:155], v[188:191], v[124:127], v[140:155]
    ds_read_b64_tr_b16 v[188:189], v213 offset:4096
    ds_read_b64_tr_b16 v[190:191], v213 offset:4352
    s_waitcnt lgkmcnt(14)
    v_mfma_f32_32x32x16_bf16 v[140:155], v[192:195], v[128:131], v[140:155]
    ds_read_b64_tr_b16 v[192:193], v213 offset:5120
    ds_read_b64_tr_b16 v[194:195], v213 offset:5376
    s_waitcnt lgkmcnt(14)
    v_mfma_f32_32x32x16_bf16 v[140:155], v[196:199], v[132:135], v[140:155]
    ds_read_b64_tr_b16 v[196:197], v213 offset:6144
    ds_read_b64_tr_b16 v[198:199], v213 offset:6400
    s_waitcnt lgkmcnt(14)
    v_mfma_f32_32x32x16_bf16 v[140:155], v[200:203], v[136:139], v[140:155]
    v_mfma_f32_32x32x16_bf16 v[140:155], v[216:219], v[220:223], v[140:155]
    s_add_u32 s48, s48, 32768
    s_and_b32 s48, s48, 131071
    v_add_u32 v212, s48, v7
    s_sub_u32 s49, s49, 1
    s_cmp_lg_u32 s49, 0
    s_cbranch_scc1 proj_f_loop
proj_f_endA:
    s_nop 15
    s_lshl_b32 s60, s50, 11
    s_add_u32 s60, s60, s51
    s_add_u32 s50, s50, 1
    v_mul_f32 v226, v140, v140
    v_mul_f32 v227, v141, v141
    v_mul_f32 v228, v142, v142
    v_mul_f32 v229, v143, v143
    v_fma_f32 v226, v226, s62, v225
    v_fma_f32 v227, v227, s62, v225
    v_fma_f32 v228, v228, s62, v225
    v_fma_f32 v229, v229, s62, v225
    v_mul_f32 v226, v226, v140
    v_mul_f32 v227, v227, v141
    v_mul_f32 v228, v228, v142
    v_mul_f32 v229, v229, v143
    v_exp_f32 v226, v226
    v_exp_f32 v227, v227
    v_exp_f32 v228, v228
    v_exp_f32 v229, v229
    v_add_f32 v226, 1.0, v226
    v_add_f32 v227, 1.0, v227
    v_add_f32 v228, 1.0, v228
    v_add_f32 v229, 1.0, v229
    v_rcp_f32 v226, v226
    v_rcp_f32 v227, v227
    v_rcp_f32 v228, v228
    v_rcp_f32 v229, v229
    v_mul_f32 v140, v140, v226
    v_mul_f32 v141, v141, v227
    v_mul_f32 v142, v142, v228
    v_mul_f32 v143, v143, v229
    v_mul_f32 v226, v144, v144
    v_mul_f32 v227, v145, v145
    v_mul_f32 v228, v146, v146
    v_mul_f32 v229, v147, v147
    v_fma_f32 v226, v226, s62, v225
    v_fma_f32 v227, v227, s62, v225
    v_fma_f32 v228, v228, s62, v225
    v_fma_f32 v229, v229, s62, v225
    v_mul_f32 v226, v226, v144
    v_mul_f32 v227, v227, v145
    v_mul_f32 v228, v228, v146
    v_mul_f32 v229, v229, v147
    v_exp_f32 v226, v226
    v_exp_f32 v227, v227
    v_exp_f32 v228, v228
    v_exp_f32 v229, v229
    v_add_f32 v226, 1.0, v226
    v_add_f32 v227, 1.0, v227
    v_add_f32 v228, 1.0, v228
    v_add_f32 v229, 1.0, v229
    v_rcp_f32 v226, v226
    v_rcp_f32 v227, v227
    v_rcp_f32 v228, v228
    v_rcp_f32 v229, v229
    v_mul_f32 v144, v144, v226
    v_mul_f32 v145, v145, v227
    v_mul_f32 v146, v146, v228
    v_mul_f32 v147, v147, v229
    v_mul_f32 v226, v148, v148
    v_mul_f32 v227, v149, v149
    v_mul_f32 v228, v150, v150
    v_mul_f32 v229, v151, v151
    v_fma_f32 v226, v226, s62, v225
    v_fma_f32 v227, v227, s62, v225
    v_fma_f32 v228, v228, s62, v225
    v_fma_f32 v229, v229, s62, v225
    v_mul_f32 v226, v226, v148
    v_mul_f32 v227, v227, v149
    v_mul_f32 v228, v228, v150
    v_mul_f32 v229, v229, v151
    v_exp_f32 v226, v226
    v_exp_f32 v227, v227
    v_exp_f32 v228, v228
    v_exp_f32 v229, v229
    v_add_f32 v226, 1.0, v226
    v_add_f32 v227, 1.0, v227
    v_add_f32 v228, 1.0, v228
    v_add_f32 v229, 1.0, v229
    v_rcp_f32 v226, v226
    v_rcp_f32 v227, v227
    v_rcp_f32 v228, v228
    v_rcp_f32 v229, v229
    v_mul_f32 v148, v148, v226
    v_mul_f32 v149, v149, v227
    v_mul_f32 v150, v150, v228
    v_mul_f32 v151, v151, v229
    v_mul_f32 v226, v152, v152
    v_mul_f32 v227, v153, v153
    v_mul_f32 v228, v154, v154
    v_mul_f32 v229, v155, v155
    v_fma_f32 v226, v226, s62, v225
    v_fma_f32 v227, v227, s62, v225
    v_fma_f32 v228, v228, s62, v225
    v_fma_f32 v229, v229, s62, v225
    v_mul_f32 v226, v226, v152
    v_mul_f32 v227, v227, v153
    v_mul_f32 v228, v228, v154
    v_mul_f32 v229, v229, v155
    v_exp_f32 v226, v226
    v_exp_f32 v227, v227
    v_exp_f32 v228, v228
    v_exp_f32 v229, v229
    v_add_f32 v226, 1.0, v226
    v_add_f32 v227, 1.0, v227
    v_add_f32 v228, 1.0, v228
    v_add_f32 v229, 1.0, v229
    v_rcp_f32 v226, v226
    v_rcp_f32 v227, v227
    v_rcp_f32 v228, v228
    v_rcp_f32 v229, v229
    v_mul_f32 v152, v152, v226
    v_mul_f32 v153, v153, v227
    v_mul_f32 v154, v154, v228
    v_mul_f32 v155, v155, v229
    v_cvt_pk_bf16_f32 v204, v140, v141
    v_cvt_pk_bf16_f32 v205, v142, v143
    v_cvt_pk_bf16_f32 v206, v144, v145
    v_cvt_pk_bf16_f32 v207, v146, v147
    v_cvt_pk_bf16_f32 v208, v148, v149
    v_cvt_pk_bf16_f32 v209, v150, v151
    v_cvt_pk_bf16_f32 v210, v152, v153
    v_cvt_pk_bf16_f32 v211, v154, v155
    buffer_store_dwordx4 v[204:207], v215, s[36:39], s60 offen
    buffer_store_dwordx4 v[208:211], v215, s[36:39], s60 offen offset:1024
    s_waitcnt vmcnt(0)
    s_branch proj_end
proj_f_endB:
    s_nop 15
    s_lshl_b32 s60, s50, 11
    s_add_u32 s60, s60, s51
    s_add_u32 s50, s50, 1
    v_mul_f32 v226, v156, v156
    v_mul_f32 v227, v157, v157
    v_mul_f32 v228, v158, v158
    v_mul_f32 v229, v159, v159
    v_fma_f32 v226, v226, s62, v225
    v_fma_f32 v227, v227, s62, v225
    v_fma_f32 v228, v228, s62, v225
    v_fma_f32 v229, v229, s62, v225
    v_mul_f32 v226, v226, v156
    v_mul_f32 v227, v227, v157
    v_mul_f32 v228, v228, v158
    v_mul_f32 v229, v229, v159
    v_exp_f32 v226, v226
    v_exp_f32 v227, v227
    v_exp_f32 v228, v228
    v_exp_f32 v229, v229
    v_add_f32 v226, 1.0, v226
    v_add_f32 v227, 1.0, v227
    v_add_f32 v228, 1.0, v228
    v_add_f32 v229, 1.0, v229
    v_rcp_f32 v226, v226
    v_rcp_f32 v227, v227
    v_rcp_f32 v228, v228
    v_rcp_f32 v229, v229
    v_mul_f32 v156, v156, v226
    v_mul_f32 v157, v157, v227
    v_mul_f32 v158, v158, v228
    v_mul_f32 v159, v159, v229
    v_mul_f32 v226, v160, v160
    v_mul_f32 v227, v161, v161
    v_mul_f32 v228, v162, v162
    v_mul_f32 v229, v163, v163
    v_fma_f32 v226, v226, s62, v225
    v_fma_f32 v227, v227, s62, v225
    v_fma_f32 v228, v228, s62, v225
    v_fma_f32 v229, v229, s62, v225
    v_mul_f32 v226, v226, v160
    v_mul_f32 v227, v227, v161
    v_mul_f32 v228, v228, v162
    v_mul_f32 v229, v229, v163
    v_exp_f32 v226, v226
    v_exp_f32 v227, v227
    v_exp_f32 v228, v228
    v_exp_f32 v229, v229
    v_add_f32 v226, 1.0, v226
    v_add_f32 v227, 1.0, v227
    v_add_f32 v228, 1.0, v228
    v_add_f32 v229, 1.0, v229
    v_rcp_f32 v226, v226
    v_rcp_f32 v227, v227
    v_rcp_f32 v228, v228
    v_rcp_f32 v229, v229
    v_mul_f32 v160, v160, v226
    v_mul_f32 v161, v161, v227
    v_mul_f32 v162, v162, v228
    v_mul_f32 v163, v163, v229
    v_mul_f32 v226, v164, v164
    v_mul_f32 v227, v165, v165
    v_mul_f32 v228, v166, v166
    v_mul_f32 v229, v167, v167
    v_fma_f32 v226, v226, s62, v225
    v_fma_f32 v227, v227, s62, v225
    v_fma_f32 v228, v228, s62, v225
    v_fma_f32 v229, v229, s62, v225
    v_mul_f32 v226, v226, v164
    v_mul_f32 v227, v227, v165
    v_mul_f32 v228, v228, v166
    v_mul_f32 v229, v229, v167
    v_exp_f32 v226, v226
    v_exp_f32 v227, v227
    v_exp_f32 v228, v228
    v_exp_f32 v229, v229
    v_add_f32 v226, 1.0, v226
    v_add_f32 v227, 1.0, v227
    v_add_f32 v228, 1.0, v228
    v_add_f32 v229, 1.0, v229
    v_rcp_f32 v226, v226
    v_rcp_f32 v227, v227
    v_rcp_f32 v228, v228
    v_rcp_f32 v229, v229
    v_mul_f32 v164, v164, v226
    v_mul_f32 v165, v165, v227
    v_mul_f32 v166, v166, v228
    v_mul_f32 v167, v167, v229
    v_mul_f32 v226, v168, v168
    v_mul_f32 v227, v169, v169
    v_mul_f32 v228, v170, v170
    v_mul_f32 v229, v171, v171
    v_fma_f32 v226, v226, s62, v225
    v_fma_f32 v227, v227, s62, v225
    v_fma_f32 v228, v228, s62, v225
    v_fma_f32 v229, v229, s62, v225
    v_mul_f32 v226, v226, v168
    v_mul_f32 v227, v227, v169
    v_mul_f32 v228, v228, v170
    v_mul_f32 v229, v229, v171
    v_exp_f32 v226, v226
    v_exp_f32 v227, v227
    v_exp_f32 v228, v228
    v_exp_f32 v229, v229
    v_add_f32 v226, 1.0, v226
    v_add_f32 v227, 1.0, v227
    v_add_f32 v228, 1.0, v228
    v_add_f32 v229, 1.0, v229
    v_rcp_f32 v226, v226
    v_rcp_f32 v227, v227
    v_rcp_f32 v228, v228
    v_rcp_f32 v229, v229
    v_mul_f32 v168, v168, v226
    v_mul_f32 v169, v169, v227
    v_mul_f32 v170, v170, v228
    v_mul_f32 v171, v171, v229
    v_cvt_pk_bf16_f32 v204, v156, v157
    v_cvt_pk_bf16_f32 v205, v158, v159
    v_cvt_pk_bf16_f32 v206, v160, v161
    v_cvt_pk_bf16_f32 v207, v162, v163
    v_cvt_pk_bf16_f32 v208, v164, v165
    v_cvt_pk_bf16_f32 v209, v166, v167
    v_cvt_pk_bf16_f32 v210, v168, v169
    v_cvt_pk_bf16_f32 v211, v170, v171
    buffer_store_dwordx4 v[204:207], v215, s[36:39], s60 offen
    buffer_store_dwordx4 v[208:211], v215, s[36:39], s60 offen offset:1024
    s_waitcnt vmcnt(0)
    s_branch proj_end
proj_end:
    s_endpgm
.section .rodata,"a"
.p2align 6
.amdhsa_kernel proj_kernel
  .amdhsa_next_free_vgpr 232
  .amdhsa_next_free_sgpr 67
  .amdhsa_accum_offset 232
  .amdhsa_group_segment_fixed_size 0
  .amdhsa_kernarg_size 112
  .amdhsa_user_sgpr_count 2
  .amdhsa_user_sgpr_kernarg_segment_ptr 1
  .amdhsa_system_sgpr_workgroup_id_x 1
.end_amdhsa_kernel

.text
.globl attn_kernel
.p2align 8
.type attn_kernel,@function
attn_kernel:
    s_cmp_ge_u32 s2, 256
    s_cbranch_scc1 attn_end
    s_load_dwordx2 s[4:5], s[0:1], 104
    v_lshrrev_b32 v1, 6, v0
    v_and_b32 v2, 63, v0
    v_readfirstlane_b32 s6, v1
    s_and_b32 s7, s6, 3
    s_lshr_b32 s8, s6, 2
    s_lshr_b32 s11, s2, 3
    s_and_b32 s10, s11, 7
    s_lshr_b32 s11, s11, 3
    s_and_b32 s9, s2, 7
    s_lshl_b32 s9, s9, 2
    s_add_u32 s9, s9, s11
    s_waitcnt lgkmcnt(0)
    s_mov_b32 s16, s4
    s_mov_b32 s17, s5
    s_mov_b32 s18, 0x10000000
    s_mov_b32 s19, 0x20000
    s_mov_b32 s20, 0x3e0293ee
    s_mov_b32 s22, 0xbe0293ee
    s_mov_b32 s23, 0xf149f2ca
    s_mov_b32 s24, 0x427af233
    s_mov_b32 s25, 0
    s_mov_b32 s38, 0x40000000
    s_mov_b32 s21, s20
    v_mov_b32 v224, 0xff800000
    v_lshlrev_b32 v226, 4, v2
    s_lshl_b32 s11, s8, 15
    s_add_u32 s11, s11, 0
    v_add_u32 v227, s11, v226
    s_add_u32 s11, s11, 65536
    v_add_u32 v229, s11, v226
    s_lshl_b32 s11, s8, 15
    s_add_u32 s11, s11, 16384
    v_add_u32 v228, s11, v226
    s_add_u32 s11, s11, 65536
    v_add_u32 v230, s11, v226
    s_lshl_b32 s11, s7, 14
    v_add_u32 v231, s11, v226
    v_and_b32 v225, 31, v2
    s_lshl_b32 s11, s7, 5
    s_lshl_b32 s12, s8, 6
    s_sub_u32 s11, s11, s12
    v_add_u32 v225, s11, v225
    v_lshrrev_b32 v1, 5, v2
    v_lshlrev_b32 v1, 2, v1
    v_sub_u32 v225, v225, v1
    s_lshl_b32 s11, s9, 19
    s_add_u32 s39, s11, 0x1000000
    s_add_u32 s40, s11, 0x2000000
    s_mov_b32 s26, 0
attn_blk:
    s_sub_u32 s11, 15, s10
    s_cmp_eq_u32 s26, 0
    s_cselect_b32 s27, s11, s10
    v_mov_b32 v212, v224
    v_mov_b32 v213, 0
    v_mov_b32 v36, 0
    v_mov_b32 v37, 0
    v_mov_b32 v38, 0
    v_mov_b32 v39, 0
    v_mov_b32 v40, 0
    v_mov_b32 v41, 0
    v_mov_b32 v42, 0
    v_mov_b32 v43, 0
    v_mov_b32 v44, 0
    v_mov_b32 v45, 0
    v_mov_b32 v46, 0
    v_mov_b32 v47, 0
    v_mov_b32 v48, 0
    v_mov_b32 v49, 0
    v_mov_b32 v50, 0
    v_mov_b32 v51, 0
    v_mov_b32 v52, 0
    v_mov_b32 v53, 0
    v_mov_b32 v54, 0
    v_mov_b32 v55, 0
    v_mov_b32 v56, 0
    v_mov_b32 v57, 0
    v_mov_b32 v58, 0
    v_mov_b32 v59, 0
    v_mov_b32 v60, 0
    v_mov_b32 v61, 0
    v_mov_b32 v62, 0
    v_mov_b32 v63, 0
    v_mov_b32 v64, 0
    v_mov_b32 v65, 0
    v_mov_b32 v66, 0
    v_mov_b32 v67, 0
    v_mov_b32 v68, 0
    v_mov_b32 v69, 0
    v_mov_b32 v70, 0
    v_mov_b32 v71, 0
    v_mov_b32 v72, 0
    v_mov_b32 v73, 0
    v_mov_b32 v74, 0
    v_mov_b32 v75, 0
    v_mov_b32 v76, 0
    v_mov_b32 v77, 0
    v_mov_b32 v78, 0
    v_mov_b32 v79, 0
    v_mov_b32 v80, 0
    v_mov_b32 v81, 0
    v_mov_b32 v82, 0
    v_mov_b32 v83, 0
    v_mov_b32 v84, 0
    v_mov_b32 v85, 0
    v_mov_b32 v86, 0
    v_mov_b32 v87, 0
    v_mov_b32 v88, 0
    v_mov_b32 v89, 0
    v_mov_b32 v90, 0
    v_mov_b32 v91, 0
    v_mov_b32 v92, 0
    v_mov_b32 v93, 0
    v_mov_b32 v94, 0
    v_mov_b32 v95, 0
    v_mov_b32 v96, 0
    v_mov_b32 v97, 0
    v_mov_b32 v98, 0
    v_mov_b32 v99, 0
    s_lshl_b32 s11, s27, 2
    s_add_u32 s11, s11, s7
    s_lshl_b32 s29, s9, 6
    s_add_u32 s29, s29, s11
    s_lshl_b32 s29, s29, 13
    s_add_u32 s30, s29, 4096
    s_lshl_b32 s41, s11, 18
    s_lshl_b32 s12, s9, 13
    s_add_u32 s41, s41, s12
    s_add_u32 s41, s41, 0x3000000
    s_add_u32 s42, s41, 4096
    buffer_load_dwordx4 v[4:7], v226, s[16:19], s29 offen
    buffer_load_dwordx4 v[8:11], v226, s[16:19], s29 offen offset:1024
    buffer_load_dwordx4 v[12:15], v226, s[16:19], s29 offen offset:2048
    buffer_load_dwordx4 v[16:19], v226, s[16:19], s29 offen offset:3072
    buffer_load_dwordx4 v[20:23], v226, s[16:19], s30 offen
    buffer_load_dwordx4 v[24:27], v226, s[16:19], s30 offen offset:1024
    buffer_load_dwordx4 v[28:31], v226, s[16:19], s30 offen offset:2048
    buffer_load_dwordx4 v[32:35], v226, s[16:19], s30 offen offset:3072
    s_lshl_b32 s11, s8, 14
    s_add_u32 s11, s11, s39
    s_lshl_b32 s12, s7, 12
    s_add_u32 s11, s11, s12
    s_lshl_b32 s36, s8, 15
    s_add_u32 s36, s36, s12
    s_mov_b32 m0, s36
    s_nop 0
    buffer_load_dwordx4 v226, s[16:19], s11 offen lds
    buffer_load_dwordx4 v226, s[16:19], s11 offen offset:1024 lds
    buffer_load_dwordx4 v226, s[16:19], s11 offen offset:2048 lds
    buffer_load_dwordx4 v226, s[16:19], s11 offen offset:3072 lds
    s_add_u32 s11, s11, 32768
    s_add_u32 s36, s36, 16384
    s_mov_b32 m0, s36
    s_nop 0
    buffer_load_dwordx4 v226, s[16:19], s11 offen lds
    buffer_load_dwordx4 v226, s[16:19], s11 offen offset:1024 lds
    buffer_load_dwordx4 v226, s[16:19], s11 offen offset:2048 lds
    buffer_load_dwordx4 v226, s[16:19], s11 offen offset:3072 lds
    s_bfe_u32 s11, s6, 0x10001
    s_and_b32 s12, s6, 1
    s_lshl_b32 s12, s12, 13
    s_lshl_b32 s31, s11, 14
    s_add_u32 s31, s31, s12
    s_lshl_b32 s34, s11, 15
    s_add_u32 s34, s34, s12
    s_cmp_eq_u32 s8, 0
    s_cselect_b32 s11, s39, s40
    s_add_u32 s31, s31, s11
    s_cmp_eq_u32 s8, 0
    s_cselect_b32 s11, 65536, 0
    s_add_u32 s31, s31, s11
    s_cmp_eq_u32 s8, 0
    s_cselect_b32 s11, 0, 65536
    s_add_u32 s34, s34, s11
    s_add_u32 s35, s34, 16384
    s_sub_u32 s11, s27, 1
    s_cmp_eq_u32 s27, 0
    s_cselect_b32 s11, 0, s11
    s_add_u32 s12, s27, 1
    s_cmp_eq_u32 s8, 0
    s_cselect_b32 s33, s11, s12
    s_waitcnt vmcnt(4)
    s_barrier
    ds_read_b128 v[180:183], v227
    ds_read_b128 v[184:187], v227 offset:8192
    ds_read_b128 v[188:191], v227 offset:1024
    ds_read_b128 v[192:195], v227 offset:9216
    ds_read_b128 v[196:199], v227 offset:2048
    ds_read_b128 v[200:203], v227 offset:10240
    ds_read_b128 v[204:207], v227 offset:3072
    ds_read_b128 v[208:211], v227 offset:11264
    s_waitcnt lgkmcnt(7)
    v_mfma_f32_32x32x16_bf16 v[100:115], v[180:183], v[4:7], 0
    ds_read_b128 v[180:183], v227 offset:4096
    s_waitcnt lgkmcnt(7)
    v_mfma_f32_32x32x16_bf16 v[116:131], v[184:187], v[4:7], 0
    ds_read_b128 v[184:187], v227 offset:12288
    s_waitcnt lgkmcnt(7)
    v_mfma_f32_32x32x16_bf16 v[100:115], v[188:191], v[8:11], v[100:115]
    ds_read_b128 v[188:191], v227 offset:5120
    s_waitcnt lgkmcnt(7)
    v_mfma_f32_32x32x16_bf16 v[116:131], v[192:195], v[8:11], v[116:131]
    ds_read_b128 v[192:195], v227 offset:13312
    s_waitcnt lgkmcnt(7)
    v_mfma_f32_32x32x16_bf16 v[100:115], v[196:199], v[12:15], v[100:115]
    ds_read_b128 v[196:199], v227 offset:6144
    s_waitcnt lgkmcnt(7)
    v_mfma_f32_32x32x16_bf16 v[116:131], v[200:203], v[12:15], v[116:131]
    ds_read_b128 v[200:203], v227 offset:14336
    s_waitcnt lgkmcnt(7)
    v_mfma_f32_32x32x16_bf16 v[100:115], v[204:207], v[16:19], v[100:115]
    ds_read_b128 v[204:207], v227 offset:7168
    s_waitcnt lgkmcnt(7)
    v_mfma_f32_32x32x16_bf16 v[116:131], v[208:211], v[16:19], v[116:131]
    ds_read_b128 v[208:211], v227 offset:15360
    s_waitcnt lgkmcnt(7)
    v_mfma_f32_32x32x16_bf16 v[100:115], v[180:183], v[20:23], v[100:115]
    s_waitcnt lgkmcnt(6)
    v_mfma_f32_32x32x16_bf16 v[116:131], v[184:187], v[20:23], v[116:131]
    s_waitcnt lgkmcnt(5)
    v_mfma_f32_32x32x16_bf16 v[100:115], v[188:191], v[24:27], v[100:115]
    s_waitcnt lgkmcnt(4)
    v_mfma_f32_32x32x16_bf16 v[116:131], v[192:195], v[24:27], v[116:131]
    s_waitcnt lgkmcnt(3)
    v_mfma_f32_32x32x16_bf16 v[100:115], v[196:199], v[28:31], v[100:115]
    s_waitcnt lgkmcnt(2)
    v_mfma_f32_32x32x16_bf16 v[116:131], v[200:203], v[28:31], v[116:131]
    s_waitcnt lgkmcnt(1)
    v_mfma_f32_32x32x16_bf16 v[100:115], v[204:207], v[32:35], v[100:115]
    s_waitcnt lgkmcnt(0)
    v_mfma_f32_32x32x16_bf16 v[116:131], v[208:211], v[32:35], v[116:131]
    s_cmp_eq_u32 s27, 0
    s_cbranch_scc1 attn_single
    s_waitcnt vmcnt(0)
    s_barrier
    s_cmp_lg_u32 s33, 0
    s_cselect_b32 s37, s31, s38
    s_cselect_b32 s11, 1, 0
    s_sub_u32 s33, s33, s11
    s_add_u32 s32, s37, 4096
    s_add_u32 s36, s34, 4096
    s_add_u32 s31, s31, 32768
    s_nop 1
    ds_read_b128 v[180:183], v228
    ds_read_b128 v[184:187], v228 offset:8192
    ds_read_b128 v[188:191], v228 offset:1024
    ds_read_b128 v[192:195], v228 offset:9216
    ds_read_b128 v[196:199], v228 offset:2048
    ds_read_b128 v[200:203], v228 offset:10240
    ds_read_b128 v[204:207], v228 offset:3072
    v_max3_f32 v220, v100, v101, v102
    v_max3_f32 v221, v108, v109, v110
    v_max3_f32 v222, v116, v117, v118
    v_max3_f32 v223, v124, v125, v126
    v_max3_f32 v220, v220, v103, v104
    v_max3_f32 v221, v221, v111, v112
    v_max3_f32 v222, v222, v119, v120
    v_max3_f32 v223, v223, v127, v128
    v_max3_f32 v220, v220, v105, v106
    v_max3_f32 v221, v221, v113, v114
    ds_read_b128 v[208:211], v228 offset:11264
    s_waitcnt lgkmcnt(7)
    v_mfma_f32_32x32x16_bf16 v[132:147], v[180:183], v[4:7], 0
    s_mov_b32 m0, s34
    s_nop 0
    buffer_load_dwordx4 v226, s[16:19], s37 offen lds
    v_max3_f32 v222, v222, v121, v122
    v_max3_f32 v223, v223, v129, v130
    v_max_f32 v220, v220, v107
    v_max_f32 v221, v221, v115
    v_max_f32 v222, v222, v123
    v_max_f32 v223, v223, v131
    v_max3_f32 v220, v220, v221, v222
    ds_read_b128 v[180:183], v228 offset:4096
    s_waitcnt lgkmcnt(7)
    v_mfma_f32_32x32x16_bf16 v[148:163], v[184:187], v[4:7], 0
    v_max_f32 v220, v220, v223
    v_mov_b32 v221, v220
    s_nop 1
    v_permlane32_swap_b32 v220, v221
    v_max_f32 v220, v220, v221
    v_sub_f32 v221, v220, v212
    v_cmp_lt_f32 vcc, s24, v221
    s_cbranch_vccnz attn_rare_1
attn_back_2:
    v_fma_f32 v100, v100, s20, v216
    v_fma_f32 v101, v101, s20, v216
    v_fma_f32 v102, v102, s20, v216
    ds_read_b128 v[184:187], v228 offset:12288
    s_waitcnt lgkmcnt(7)
    v_mfma_f32_32x32x16_bf16 v[132:147], v[188:191], v[8:11], v[132:147]
    s_mov_b32 m0, s34
    s_nop 0
    buffer_load_dwordx4 v226, s[16:19], s37 offen offset:1024 lds
    v_fma_f32 v103, v103, s20, v216
    v_exp_f32 v100, v100
    v_exp_f32 v101, v101
    v_exp_f32 v102, v102
    v_exp_f32 v103, v103
    v_fma_f32 v104, v104, s20, v216
    v_fma_f32 v105, v105, s20, v216
    v_fma_f32 v106, v106, s20, v216
    ds_read_b128 v[188:191], v228 offset:5120
    s_waitcnt lgkmcnt(7)
    v_mfma_f32_32x32x16_bf16 v[148:163], v[192:195], v[8:11], v[148:163]
    v_fma_f32 v107, v107, s20, v216
    v_exp_f32 v104, v104
    v_exp_f32 v105, v105
    v_exp_f32 v106, v106
    v_exp_f32 v107, v107
    v_fma_f32 v108, v108, s20, v216
    v_fma_f32 v109, v109, s20, v216
    v_fma_f32 v110, v110, s20, v216
    ds_read_b128 v[192:195], v228 offset:13312
    s_waitcnt lgkmcnt(7)
    v_mfma_f32_32x32x16_bf16 v[132:147], v[196:199], v[12:15], v[132:147]
    s_mov_b32 m0, s34
    s_nop 0
    buffer_load_dwordx4 v226, s[16:19], s37 offen offset:2048 lds
    v_fma_f32 v111, v111, s20, v216
    v_exp_f32 v108, v108
    v_exp_f32 v109, v109
    v_exp_f32 v110, v110
    v_exp_f32 v111, v111
    v_fma_f32 v112, v112, s20, v216
    v_fma_f32 v113, v113, s20, v216
    ds_read_b128 v[196:199], v228 offset:6144
    s_waitcnt lgkmcnt(7)
    v_mfma_f32_32x32x16_bf16 v[148:163], v[200:203], v[12:15], v[148:163]
    v_fma_f32 v114, v114, s20, v216
    v_fma_f32 v115, v115, s20, v216
    v_exp_f32 v112, v112
    v_exp_f32 v113, v113
    v_exp_f32 v114, v114
    v_exp_f32 v115, v115
    v_fma_f32 v116, v116, s20, v216
    v_fma_f32 v117, v117, s20, v216
    ds_read_b128 v[200:203], v228 offset:14336
    s_waitcnt lgkmcnt(7)
    v_mfma_f32_32x32x16_bf16 v[132:147], v[204:207], v[16:19], v[132:147]
    s_mov_b32 m0, s34
    s_nop 0
    buffer_load_dwordx4 v226, s[16:19], s37 offen offset:3072 lds
    v_fma_f32 v118, v118, s20, v216
    v_fma_f32 v119, v119, s20, v216
    v_exp_f32 v116, v116
    v_exp_f32 v117, v117
    v_exp_f32 v118, v118
    v_exp_f32 v119, v119
    v_fma_f32 v120, v120, s20, v216
    v_fma_f32 v121, v121, s20, v216
    ds_read_b128 v[204:207], v228 offset:7168
    s_waitcnt lgkmcnt(7)
    v_mfma_f32_32x32x16_bf16 v[148:163], v[208:211], v[16:19], v[148:163]
    v_fma_f32 v122, v122, s20, v216
    v_fma_f32 v123, v123, s20, v216
    v_exp_f32 v120, v120
    v_exp_f32 v121, v121
    v_exp_f32 v122, v122
    v_exp_f32 v123, v123
    v_fma_f32 v124, v124, s20, v216
    v_fma_f32 v125, v125, s20, v216
    ds_read_b128 v[208:211], v228 offset:15360
    s_waitcnt lgkmcnt(7)
    v_mfma_f32_32x32x16_bf16 v[132:147], v[180:183], v[20:23], v[132:147]
    s_mov_b32 m0, s36
    s_nop 0
    buffer_load_dwordx4 v226, s[16:19], s32 offen lds
    v_fma_f32 v126, v126, s20, v216
    v_fma_f32 v127, v127, s20, v216
    v_exp_f32 v124, v124
    v_exp_f32 v125, v125
    v_exp_f32 v126, v126
    v_exp_f32 v127, v127
    v_fma_f32 v128, v128, s20, v216
    s_waitcnt lgkmcnt(6)
    v_mfma_f32_32x32x16_bf16 v[148:163], v[184:187], v[20:23], v[148:163]
    v_fma_f32 v129, v129, s20, v216
    v_fma_f32 v130, v130, s20, v216
    v_fma_f32 v131, v131, s20, v216
    v_exp_f32 v128, v128
    v_exp_f32 v129, v129
    v_exp_f32 v130, v130
    v_exp_f32 v131, v131
    v_add_f32 v220, v100, v101
    s_waitcnt lgkmcnt(5)
    v_mfma_f32_32x32x16_bf16 v[132:147], v[188:191], v[24:27], v[132:147]
    s_mov_b32 m0, s36
    s_nop 0
    buffer_load_dwordx4 v226, s[16:19], s32 offen offset:1024 lds
    v_add_f32 v221, v108, v109
    v_add_f32 v222, v116, v117
    v_add_f32 v223, v124, v125
    v_add_f32 v220, v220, v102
    v_add_f32 v221, v221, v110
    v_add_f32 v222, v222, v118
    v_add_f32 v223, v223, v126
    v_add_f32 v220, v220, v103
    s_waitcnt lgkmcnt(4)
    v_mfma_f32_32x32x16_bf16 v[148:163], v[192:195], v[24:27], v[148:163]
    v_add_f32 v221, v221, v111
    v_add_f32 v222, v222, v119
    v_add_f32 v223, v223, v127
    v_add_f32 v220, v220, v104
    v_add_f32 v221, v221, v112
    v_add_f32 v222, v222, v120
    v_add_f32 v223, v223, v128
    v_add_f32 v220, v220, v105
    s_waitcnt lgkmcnt(3)
    v_mfma_f32_32x32x16_bf16 v[132:147], v[196:199], v[28:31], v[132:147]
    s_mov_b32 m0, s36
    s_nop 0
    buffer_load_dwordx4 v226, s[16:19], s32 offen offset:2048 lds
    v_add_f32 v221, v221, v113
    v_add_f32 v222, v222, v121
    v_add_f32 v223, v223, v129
    v_add_f32 v220, v220, v106
    v_add_f32 v221, v221, v114
    v_add_f32 v222, v222, v122
    v_add_f32 v223, v223, v130
    s_waitcnt lgkmcnt(2)
    v_mfma_f32_32x32x16_bf16 v[148:163], v[200:203], v[28:31], v[148:163]
    v_add_f32 v220, v220, v107
    v_add_f32 v221, v221, v115
    v_add_f32 v222, v222, v123
    v_add_f32 v223, v223, v131
    v_add_f32 v220, v220, v221
    v_add_f32 v222, v222, v223
    v_add_f32 v220, v220, v222
    v_add_f32 v213, v213, v220
    s_waitcnt lgkmcnt(1)
    v_mfma_f32_32x32x16_bf16 v[132:147], v[204:207], v[32:35], v[132:147]
    s_mov_b32 m0, s36
    s_nop 0
    buffer_load_dwordx4 v226, s[16:19], s32 offen offset:3072 lds
    v_cvt_pk_bf16_f32 v164, v100, v101
    v_cvt_pk_bf16_f32 v165, v102, v103
    v_cvt_pk_bf16_f32 v166, v104, v105
    v_cvt_pk_bf16_f32 v167, v106, v107
    v_cvt_pk_bf16_f32 v168, v108, v109
    v_cvt_pk_bf16_f32 v169, v110, v111
    v_cvt_pk_bf16_f32 v170, v112, v113
    v_cvt_pk_bf16_f32 v171, v114, v115
    s_waitcnt lgkmcnt(0)
    v_mfma_f32_32x32x16_bf16 v[148:163], v[208:211], v[32:35], v[148:163]
    v_cvt_pk_bf16_f32 v172, v116, v117
    v_cvt_pk_bf16_f32 v173, v118, v119
    v_cvt_pk_bf16_f32 v174, v120, v121
    v_cvt_pk_bf16_f32 v175, v122, v123
    v_cvt_pk_bf16_f32 v176, v124, v125
    v_cvt_pk_bf16_f32 v177, v126, v127
    v_cvt_pk_bf16_f32 v178, v128, v129
    v_cvt_pk_bf16_f32 v179, v130, v131
    s_cmp_eq_u32 s25, 0
    s_cbranch_scc1 attn_noresc_3
    v_pk_mul_f32 v[36:37], v[36:37], v[214:215] op_sel_hi:[1,0]
    v_pk_mul_f32 v[38:39], v[38:39], v[214:215] op_sel_hi:[1,0]
    v_pk_mul_f32 v[40:41], v[40:41], v[214:215] op_sel_hi:[1,0]
    v_pk_mul_f32 v[42:43], v[42:43], v[214:215] op_sel_hi:[1,0]
    v_pk_mul_f32 v[44:45], v[44:45], v[214:215] op_sel_hi:[1,0]
    v_pk_mul_f32 v[46:47], v[46:47], v[214:215] op_sel_hi:[1,0]
    v_pk_mul_f32 v[48:49], v[48:49], v[214:215] op_sel_hi:[1,0]
    v_pk_mul_f32 v[50:51], v[50:51], v[214:215] op_sel_hi:[1,0]
    v_pk_mul_f32 v[52:53], v[52:53], v[214:215] op_sel_hi:[1,0]
    v_pk_mul_f32 v[54:55], v[54:55], v[214:215] op_sel_hi:[1,0]
    v_pk_mul_f32 v[56:57], v[56:57], v[214:215] op_sel_hi:[1,0]
    v_pk_mul_f32 v[58:59], v[58:59], v[214:215] op_sel_hi:[1,0]
    v_pk_mul_f32 v[60:61], v[60:61], v[214:215] op_sel_hi:[1,0]
    v_pk_mul_f32 v[62:63], v[62:63], v[214:215] op_sel_hi:[1,0]
    v_pk_mul_f32 v[64:65], v[64:65], v[214:215] op_sel_hi:[1,0]
    v_pk_mul_f32 v[66:67], v[66:67], v[214:215] op_sel_hi:[1,0]
    v_pk_mul_f32 v[68:69], v[68:69], v[214:215] op_sel_hi:[1,0]
    v_pk_mul_f32 v[70:71], v[70:71], v[214:215] op_sel_hi:[1,0]
    v_pk_mul_f32 v[72:73], v[72:73], v[214:215] op_sel_hi:[1,0]
    v_pk_mul_f32 v[74:75], v[74:75], v[214:215] op_sel_hi:[1,0]
    v_pk_mul_f32 v[76:77], v[76:77], v[214:215] op_sel_hi:[1,0]
    v_pk_mul_f32 v[78:79], v[78:79], v[214:215] op_sel_hi:[1,0]
    v_pk_mul_f32 v[80:81], v[80:81], v[214:215] op_sel_hi:[1,0]
    v_pk_mul_f32 v[82:83], v[82:83], v[214:215] op_sel_hi:[1,0]
    v_pk_mul_f32 v[84:85], v[84:85], v[214:215] op_sel_hi:[1,0]
    v_pk_mul_f32 v[86:87], v[86:87], v[214:215] op_sel_hi:[1,0]
    v_pk_mul_f32 v[88:89], v[88:89], v[214:215] op_sel_hi:[1,0]
    v_pk_mul_f32 v[90:91], v[90:91], v[214:215] op_sel_hi:[1,0]
    v_pk_mul_f32 v[92:93], v[92:93], v[214:215] op_sel_hi:[1,0]
    v_pk_mul_f32 v[94:95], v[94:95], v[214:215] op_sel_hi:[1,0]
    v_pk_mul_f32 v[96:97], v[96:97], v[214:215] op_sel_hi:[1,0]
    v_pk_mul_f32 v[98:99], v[98:99], v[214:215] op_sel_hi:[1,0]
    s_mov_b32 s25, 0
attn_noresc_3:
    s_mov_b32 s28, 1
attn_loop:
    s_cmp_eq_u32 s28, s27
    s_cbranch_scc1 attn_last1
    s_waitcnt vmcnt(0)
    s_barrier
    s_cmp_lg_u32 s33, 0
    s_cselect_b32 s37, s31, s38
    s_cselect_b32 s11, 1, 0
    s_sub_u32 s33, s33, s11
    s_add_u32 s32, s37, 4096
    s_add_u32 s36, s35, 4096
    s_add_u32 s31, s31, 32768
    s_nop 1
    ds_read_b128 v[180:183], v229
    ds_read_b128 v[184:187], v229 offset:1024
    ds_read_b128 v[188:191], v229 offset:2048
    ds_read_b128 v[192:195], v229 offset:3072
    ds_read_b128 v[196:199], v229 offset:4096
    ds_read_b128 v[200:203], v229 offset:5120
    ds_read_b128 v[204:207], v229 offset:6144
    v_max3_f32 v220, v132, v133, v134
    v_max3_f32 v221, v140, v141, v142
    v_max3_f32 v222, v148, v149, v150
    v_max3_f32 v223, v156, v157, v158
    v_max3_f32 v220, v220, v135, v136
    v_max3_f32 v221, v221, v143, v144
    v_max3_f32 v222, v222, v151, v152
    v_max3_f32 v223, v223, v159, v160
    v_max3_f32 v220, v220, v137, v138
    v_max3_f32 v221, v221, v145, v146
    ds_read_b128 v[208:211], v229 offset:7168
    s_waitcnt lgkmcnt(7)
    v_mfma_f32_32x32x16_bf16 v[36:51], v[180:183], v[164:167], v[36:51]
    s_mov_b32 m0, s35
    s_nop 0
    buffer_load_dwordx4 v226, s[16:19], s37 offen lds
    v_max3_f32 v222, v222, v153, v154
    v_max3_f32 v223, v223, v161, v162
    v_max_f32 v220, v220, v139
    ds_read_b128 v[180:183], v229 offset:8192
    s_waitcnt lgkmcnt(7)
    v_mfma_f32_32x32x16_bf16 v[52:67], v[184:187], v[164:167], v[52:67]
    v_max_f32 v221, v221, v147
    v_max_f32 v222, v222, v155
    v_max_f32 v223, v223, v163
    v_max3_f32 v220, v220, v221, v222
    ds_read_b128 v[184:187], v229 offset:9216
    s_waitcnt lgkmcnt(7)
    v_mfma_f32_32x32x16_bf16 v[68:83], v[188:191], v[164:167], v[68:83]
    s_mov_b32 m0, s35
    s_nop 0
    buffer_load_dwordx4 v226, s[16:19], s37 offen offset:1024 lds
    v_max_f32 v220, v220, v223
    v_mov_b32 v221, v220
    s_nop 1
    v_permlane32_swap_b32 v220, v221
    v_max_f32 v220, v220, v221
    ds_read_b128 v[188:191], v229 offset:10240
    s_waitcnt lgkmcnt(7)
    v_mfma_f32_32x32x16_bf16 v[84:99], v[192:195], v[164:167], v[84:99]
    v_sub_f32 v221, v220, v212
    v_cmp_lt_f32 vcc, s24, v221
    s_cbranch_vccnz attn_rare_4
attn_back_5:
    v_fma_f32 v132, v132, s20, v216
    v_fma_f32 v133, v133, s20, v216
    v_fma_f32 v134, v134, s20, v216
    ds_read_b128 v[192:195], v229 offset:11264
    s_waitcnt lgkmcnt(7)
    v_mfma_f32_32x32x16_bf16 v[36:51], v[196:199], v[168:171], v[36:51]
    s_mov_b32 m0, s35
    s_nop 0
    buffer_load_dwordx4 v226, s[16:19], s37 offen offset:2048 lds
    v_fma_f32 v135, v135, s20, v216
    v_exp_f32 v132, v132
    v_exp_f32 v133, v133
    v_exp_f32 v134, v134
    ds_read_b128 v[196:199], v229 offset:12288
    s_waitcnt lgkmcnt(7)
    v_mfma_f32_32x32x16_bf16 v[52:67], v[200:203], v[168:171], v[52:67]
    v_exp_f32 v135, v135
    v_fma_f32 v136, v136, s20, v216
    v_fma_f32 v137, v137, s20, v216
    v_fma_f32 v138, v138, s20, v216
    ds_read_b128 v[200:203], v229 offset:13312
    s_waitcnt lgkmcnt(7)
    v_mfma_f32_32x32x16_bf16 v[68:83], v[204:207], v[168:171], v[68:83]
    s_mov_b32 m0, s35
    s_nop 0
    buffer_load_dwordx4 v226, s[16:19], s37 offen offset:3072 lds
    v_fma_f32 v139, v139, s20, v216
    v_exp_f32 v136, v136
    v_exp_f32 v137, v137
    v_exp_f32 v138, v138
    ds_read_b128 v[204:207], v229 offset:14336
    s_waitcnt lgkmcnt(7)
    v_mfma_f32_32x32x16_bf16 v[84:99], v[208:211], v[168:171], v[84:99]
    v_exp_f32 v139, v139
    v_fma_f32 v140, v140, s20, v216
    v_fma_f32 v141, v141, s20, v216
    v_fma_f32 v142, v142, s20, v216
    ds_read_b128 v[208:211], v229 offset:15360
    s_waitcnt lgkmcnt(7)
    v_mfma_f32_32x32x16_bf16 v[36:51], v[180:183], v[172:175], v[36:51]
    s_mov_b32 m0, s36
    s_nop 0
    buffer_load_dwordx4 v226, s[16:19], s32 offen lds
    v_fma_f32 v143, v143, s20, v216
    v_exp_f32 v140, v140
    v_exp_f32 v141, v141
    ds_read_b128 v[180:183], v227
    s_waitcnt lgkmcnt(7)
    v_mfma_f32_32x32x16_bf16 v[52:67], v[184:187], v[172:175], v[52:67]
    v_exp_f32 v142, v142
    v_exp_f32 v143, v143
    v_fma_f32 v144, v144, s20, v216
    v_fma_f32 v145, v145, s20, v216
    ds_read_b128 v[184:187], v227 offset:8192
    s_waitcnt lgkmcnt(7)
    v_mfma_f32_32x32x16_bf16 v[68:83], v[188:191], v[172:175], v[68:83]
    s_mov_b32 m0, s36
    s_nop 0
    buffer_load_dwordx4 v226, s[16:19], s32 offen offset:1024 lds
    v_fma_f32 v146, v146, s20, v216
    v_fma_f32 v147, v147, s20, v216
    v_exp_f32 v144, v144
    v_exp_f32 v145, v145
    ds_read_b128 v[188:191], v227 offset:1024
    s_waitcnt lgkmcnt(7)
    v_mfma_f32_32x32x16_bf16 v[84:99], v[192:195], v[172:175], v[84:99]
    v_exp_f32 v146, v146
    v_exp_f32 v147, v147
    v_fma_f32 v148, v148, s20, v216
    v_fma_f32 v149, v149, s20, v216
    ds_read_b128 v[192:195], v227 offset:9216
    s_waitcnt lgkmcnt(7)
    v_mfma_f32_32x32x16_bf16 v[36:51], v[196:199], v[176:179], v[36:51]
    s_mov_b32 m0, s36
    s_nop 0
    buffer_load_dwordx4 v226, s[16:19], s32 offen offset:2048 lds
    v_fma_f32 v150, v150, s20, v216
    v_fma_f32 v151, v151, s20, v216
    v_exp_f32 v148, v148
    v_exp_f32 v149, v149
    ds_read_b128 v[196:199], v227 offset:2048
    s_waitcnt lgkmcnt(7)
    v_mfma_f32_32x32x16_bf16 v[52:67], v[200:203], v[176:179], v[52:67]
    v_exp_f32 v150, v150
    v_exp_f32 v151, v151
    v_fma_f32 v152, v152, s20, v216
    v_fma_f32 v153, v153, s20, v216
    ds_read_b128 v[200:203], v227 offset:10240
    s_waitcnt lgkmcnt(7)
    v_mfma_f32_32x32x16_bf16 v[68:83], v[204:207], v[176:179], v[68:83]
    s_mov_b32 m0, s36
    s_nop 0
    buffer_load_dwordx4 v226, s[16:19], s32 offen offset:3072 lds
    v_fma_f32 v154, v154, s20, v216
    v_fma_f32 v155, v155, s20, v216
    v_exp_f32 v152, v152
    v_exp_f32 v153, v153
    ds_read_b128 v[204:207], v227 offset:3072
    s_waitcnt lgkmcnt(7)
    v_mfma_f32_32x32x16_bf16 v[84:99], v[208:211], v[176:179], v[84:99]
    v_exp_f32 v154, v154
    v_exp_f32 v155, v155
    v_fma_f32 v156, v156, s20, v216
    v_fma_f32 v157, v157, s20, v216
    ds_read_b128 v[208:211], v227 offset:11264
    s_waitcnt lgkmcnt(7)
    v_mfma_f32_32x32x16_bf16 v[100:115], v[180:183], v[4:7], 0
    v_fma_f32 v158, v158, s20, v216
    v_fma_f32 v159, v159, s20, v216
    v_exp_f32 v156, v156
    ds_read_b128 v[180:183], v227 offset:4096
    s_waitcnt lgkmcnt(7)
    v_mfma_f32_32x32x16_bf16 v[116:131], v[184:187], v[4:7], 0
    v_exp_f32 v157, v157
    v_exp_f32 v158, v158
    v_exp_f32 v159, v159
    v_fma_f32 v160, v160, s20, v216
    ds_read_b128 v[184:187], v227 offset:12288
    s_waitcnt lgkmcnt(7)
    v_mfma_f32_32x32x16_bf16 v[100:115], v[188:191], v[8:11], v[100:115]
    v_fma_f32 v161, v161, s20, v216
    v_fma_f32 v162, v162, s20, v216
    v_fma_f32 v163, v163, s20, v216
    v_exp_f32 v160, v160
    ds_read_b128 v[188:191], v227 offset:5120
    s_waitcnt lgkmcnt(7)
    v_mfma_f32_32x32x16_bf16 v[116:131], v[192:195], v[8:11], v[116:131]
    v_exp_f32 v161, v161
    v_exp_f32 v162, v162
    v_exp_f32 v163, v163
    v_add_f32 v220, v132, v133
    ds_read_b128 v[192:195], v227 offset:13312
    s_waitcnt lgkmcnt(7)
    v_mfma_f32_32x32x16_bf16 v[100:115], v[196:199], v[12:15], v[100:115]
    v_add_f32 v221, v140, v141
    v_add_f32 v222, v148, v149
    v_add_f32 v223, v156, v157
    v_add_f32 v220, v220, v134
    ds_read_b128 v[196:199], v227 offset:6144
    s_waitcnt lgkmcnt(7)
    v_mfma_f32_32x32x16_bf16 v[116:131], v[200:203], v[12:15], v[116:131]
    v_add_f32 v221, v221, v142
    v_add_f32 v222, v222, v150
    v_add_f32 v223, v223, v158
    v_add_f32 v220, v220, v135
    ds_read_b128 v[200:203], v227 offset:14336
    s_waitcnt lgkmcnt(7)
    v_mfma_f32_32x32x16_bf16 v[100:115], v[204:207], v[16:19], v[100:115]
    v_add_f32 v221, v221, v143
    v_add_f32 v222, v222, v151
    v_add_f32 v223, v223, v159
    v_add_f32 v220, v220, v136
    ds_read_b128 v[204:207], v227 offset:7168
    s_waitcnt lgkmcnt(7)
    v_mfma_f32_32x32x16_bf16 v[116:131], v[208:211], v[16:19], v[116:131]
    v_add_f32 v221, v221, v144
    v_add_f32 v222, v222, v152
    v_add_f32 v223, v223, v160
    v_add_f32 v220, v220, v137
    ds_read_b128 v[208:211], v227 offset:15360
    s_waitcnt lgkmcnt(7)
    v_mfma_f32_32x32x16_bf16 v[100:115], v[180:183], v[20:23], v[100:115]
    v_add_f32 v221, v221, v145
    v_add_f32 v222, v222, v153
    v_add_f32 v223, v223, v161
    s_waitcnt lgkmcnt(6)
    v_mfma_f32_32x32x16_bf16 v[116:131], v[184:187], v[20:23], v[116:131]
    v_add_f32 v220, v220, v138
    v_add_f32 v221, v221, v146
    v_add_f32 v222, v222, v154
    v_add_f32 v223, v223, v162
    s_waitcnt lgkmcnt(5)
    v_mfma_f32_32x32x16_bf16 v[100:115], v[188:191], v[24:27], v[100:115]
    v_add_f32 v220, v220, v139
    v_add_f32 v221, v221, v147
    v_add_f32 v222, v222, v155
    v_add_f32 v223, v223, v163
    s_waitcnt lgkmcnt(4)
    v_mfma_f32_32x32x16_bf16 v[116:131], v[192:195], v[24:27], v[116:131]
    v_add_f32 v220, v220, v221
    v_add_f32 v222, v222, v223
    v_add_f32 v220, v220, v222
    v_add_f32 v213, v213, v220
    s_waitcnt lgkmcnt(3)
    v_mfma_f32_32x32x16_bf16 v[100:115], v[196:199], v[28:31], v[100:115]
    v_cvt_pk_bf16_f32 v164, v132, v133
    v_cvt_pk_bf16_f32 v165, v134, v135
    v_cvt_pk_bf16_f32 v166, v136, v137
    v_cvt_pk_bf16_f32 v167, v138, v139
    s_waitcnt lgkmcnt(2)
    v_mfma_f32_32x32x16_bf16 v[116:131], v[200:203], v[28:31], v[116:131]
    v_cvt_pk_bf16_f32 v168, v140, v141
    v_cvt_pk_bf16_f32 v169, v142, v143
    v_cvt_pk_bf16_f32 v170, v144, v145
    v_cvt_pk_bf16_f32 v171, v146, v147
    s_waitcnt lgkmcnt(1)
    v_mfma_f32_32x32x16_bf16 v[100:115], v[204:207], v[32:35], v[100:115]
    v_cvt_pk_bf16_f32 v172, v148, v149
    v_cvt_pk_bf16_f32 v173, v150, v151
    v_cvt_pk_bf16_f32 v174, v152, v153
    v_cvt_pk_bf16_f32 v175, v154, v155
    s_waitcnt lgkmcnt(0)
    v_mfma_f32_32x32x16_bf16 v[116:131], v[208:211], v[32:35], v[116:131]
    v_cvt_pk_bf16_f32 v176, v156, v157
    v_cvt_pk_bf16_f32 v177, v158, v159
    v_cvt_pk_bf16_f32 v178, v160, v161
    v_cvt_pk_bf16_f32 v179, v162, v163
    s_cmp_eq_u32 s25, 0
    s_cbranch_scc1 attn_noresc_6
    v_pk_mul_f32 v[36:37], v[36:37], v[214:215] op_sel_hi:[1,0]
    v_pk_mul_f32 v[38:39], v[38:39], v[214:215] op_sel_hi:[1,0]
    v_pk_mul_f32 v[40:41], v[40:41], v[214:215] op_sel_hi:[1,0]
    v_pk_mul_f32 v[42:43], v[42:43], v[214:215] op_sel_hi:[1,0]
    v_pk_mul_f32 v[44:45], v[44:45], v[214:215] op_sel_hi:[1,0]
    v_pk_mul_f32 v[46:47], v[46:47], v[214:215] op_sel_hi:[1,0]
    v_pk_mul_f32 v[48:49], v[48:49], v[214:215] op_sel_hi:[1,0]
    v_pk_mul_f32 v[50:51], v[50:51], v[214:215] op_sel_hi:[1,0]
    v_pk_mul_f32 v[52:53], v[52:53], v[214:215] op_sel_hi:[1,0]
    v_pk_mul_f32 v[54:55], v[54:55], v[214:215] op_sel_hi:[1,0]
    v_pk_mul_f32 v[56:57], v[56:57], v[214:215] op_sel_hi:[1,0]
    v_pk_mul_f32 v[58:59], v[58:59], v[214:215] op_sel_hi:[1,0]
    v_pk_mul_f32 v[60:61], v[60:61], v[214:215] op_sel_hi:[1,0]
    v_pk_mul_f32 v[62:63], v[62:63], v[214:215] op_sel_hi:[1,0]
    v_pk_mul_f32 v[64:65], v[64:65], v[214:215] op_sel_hi:[1,0]
    v_pk_mul_f32 v[66:67], v[66:67], v[214:215] op_sel_hi:[1,0]
    v_pk_mul_f32 v[68:69], v[68:69], v[214:215] op_sel_hi:[1,0]
    v_pk_mul_f32 v[70:71], v[70:71], v[214:215] op_sel_hi:[1,0]
    v_pk_mul_f32 v[72:73], v[72:73], v[214:215] op_sel_hi:[1,0]
    v_pk_mul_f32 v[74:75], v[74:75], v[214:215] op_sel_hi:[1,0]
    v_pk_mul_f32 v[76:77], v[76:77], v[214:215] op_sel_hi:[1,0]
    v_pk_mul_f32 v[78:79], v[78:79], v[214:215] op_sel_hi:[1,0]
    v_pk_mul_f32 v[80:81], v[80:81], v[214:215] op_sel_hi:[1,0]
    v_pk_mul_f32 v[82:83], v[82:83], v[214:215] op_sel_hi:[1,0]
    v_pk_mul_f32 v[84:85], v[84:85], v[214:215] op_sel_hi:[1,0]
    v_pk_mul_f32 v[86:87], v[86:87], v[214:215] op_sel_hi:[1,0]
    v_pk_mul_f32 v[88:89], v[88:89], v[214:215] op_sel_hi:[1,0]
    v_pk_mul_f32 v[90:91], v[90:91], v[214:215] op_sel_hi:[1,0]
    v_pk_mul_f32 v[92:93], v[92:93], v[214:215] op_sel_hi:[1,0]
    v_pk_mul_f32 v[94:95], v[94:95], v[214:215] op_sel_hi:[1,0]
    v_pk_mul_f32 v[96:97], v[96:97], v[214:215] op_sel_hi:[1,0]
    v_pk_mul_f32 v[98:99], v[98:99], v[214:215] op_sel_hi:[1,0]
    s_mov_b32 s25, 0
attn_noresc_6:
    s_add_u32 s28, s28, 1
    s_cmp_eq_u32 s28, s27
    s_cbranch_scc1 attn_last0
    s_waitcnt vmcnt(0)
    s_barrier
    s_cmp_lg_u32 s33, 0
    s_cselect_b32 s37, s31, s38
    s_cselect_b32 s11, 1, 0
    s_sub_u32 s33, s33, s11
    s_add_u32 s32, s37, 4096
    s_add_u32 s36, s34, 4096
    s_add_u32 s31, s31, 32768
    s_nop 1
    ds_read_b128 v[180:183], v230
    ds_read_b128 v[184:187], v230 offset:1024
    ds_read_b128 v[188:191], v230 offset:2048
    ds_read_b128 v[192:195], v230 offset:3072
    ds_read_b128 v[196:199], v230 offset:4096
    ds_read_b128 v[200:203], v230 offset:5120
    ds_read_b128 v[204:207], v230 offset:6144
    v_max3_f32 v220, v100, v101, v102
    v_max3_f32 v221, v108, v109, v110
    v_max3_f32 v222, v116, v117, v118
    v_max3_f32 v223, v124, v125, v126
    v_max3_f32 v220, v220, v103, v104
    v_max3_f32 v221, v221, v111, v112
    v_max3_f32 v222, v222, v119, v120
    v_max3_f32 v223, v223, v127, v128
    v_max3_f32 v220, v220, v105, v106
    v_max3_f32 v221, v221, v113, v114
    ds_read_b128 v[208:211], v230 offset:7168
    s_waitcnt lgkmcnt(7)
    v_mfma_f32_32x32x16_bf16 v[36:51], v[180:183], v[164:167], v[36:51]
    s_mov_b32 m0, s34
    s_nop 0
    buffer_load_dwordx4 v226, s[16:19], s37 offen lds
    v_max3_f32 v222, v222, v121, v122
    v_max3_f32 v223, v223, v129, v130
    v_max_f32 v220, v220, v107
    ds_read_b128 v[180:183], v230 offset:8192
    s_waitcnt lgkmcnt(7)
    v_mfma_f32_32x32x16_bf16 v[52:67], v[184:187], v[164:167], v[52:67]
    v_max_f32 v221, v221, v115
    v_max_f32 v222, v222, v123
    v_max_f32 v223, v223, v131
    v_max3_f32 v220, v220, v221, v222
    ds_read_b128 v[184:187], v230 offset:9216
    s_waitcnt lgkmcnt(7)
    v_mfma_f32_32x32x16_bf16 v[68:83], v[188:191], v[164:167], v[68:83]
    s_mov_b32 m0, s34
    s_nop 0
    buffer_load_dwordx4 v226, s[16:19], s37 offen offset:1024 lds
    v_max_f32 v220, v220, v223
    v_mov_b32 v221, v220
    s_nop 1
    v_permlane32_swap_b32 v220, v221
    v_max_f32 v220, v220, v221
    ds_read_b128 v[188:191], v230 offset:10240
    s_waitcnt lgkmcnt(7)
    v_mfma_f32_32x32x16_bf16 v[84:99], v[192:195], v[164:167], v[84:99]
    v_sub_f32 v221, v220, v212
    v_cmp_lt_f32 vcc, s24, v221
    s_cbranch_vccnz attn_rare_7
attn_back_8:
    v_fma_f32 v100, v100, s20, v216
    v_fma_f32 v101, v101, s20, v216
    v_fma_f32 v102, v102, s20, v216
    ds_read_b128 v[192:195], v230 offset:11264
    s_waitcnt lgkmcnt(7)
    v_mfma_f32_32x32x16_bf16 v[36:51], v[196:199], v[168:171], v[36:51]
    s_mov_b32 m0, s34
    s_nop 0
    buffer_load_dwordx4 v226, s[16:19], s37 offen offset:2048 lds
    v_fma_f32 v103, v103, s20, v216
    v_exp_f32 v100, v100
    v_exp_f32 v101, v101
    v_exp_f32 v102, v102
    ds_read_b128 v[196:199], v230 offset:12288
    s_waitcnt lgkmcnt(7)
    v_mfma_f32_32x32x16_bf16 v[52:67], v[200:203], v[168:171], v[52:67]
    v_exp_f32 v103, v103
    v_fma_f32 v104, v104, s20, v216
    v_fma_f32 v105, v105, s20, v216
    v_fma_f32 v106, v106, s20, v216
    ds_read_b128 v[200:203], v230 offset:13312
    s_waitcnt lgkmcnt(7)
    v_mfma_f32_32x32x16_bf16 v[68:83], v[204:207], v[168:171], v[68:83]
    s_mov_b32 m0, s34
    s_nop 0
    buffer_load_dwordx4 v226, s[16:19], s37 offen offset:3072 lds
    v_fma_f32 v107, v107, s20, v216
    v_exp_f32 v104, v104
    v_exp_f32 v105, v105
    v_exp_f32 v106, v106
    ds_read_b128 v[204:207], v230 offset:14336
    s_waitcnt lgkmcnt(7)
    v_mfma_f32_32x32x16_bf16 v[84:99], v[208:211], v[168:171], v[84:99]
    v_exp_f32 v107, v107
    v_fma_f32 v108, v108, s20, v216
    v_fma_f32 v109, v109, s20, v216
    v_fma_f32 v110, v110, s20, v216
    ds_read_b128 v[208:211], v230 offset:15360
    s_waitcnt lgkmcnt(7)
    v_mfma_f32_32x32x16_bf16 v[36:51], v[180:183], v[172:175], v[36:51]
    s_mov_b32 m0, s36
    s_nop 0
    buffer_load_dwordx4 v226, s[16:19], s32 offen lds
    v_fma_f32 v111, v111, s20, v216
    v_exp_f32 v108, v108
    v_exp_f32 v109, v109
    ds_read_b128 v[180:183], v228
    s_waitcnt lgkmcnt(7)
    v_mfma_f32_32x32x16_bf16 v[52:67], v[184:187], v[172:175], v[52:67]
    v_exp_f32 v110, v110
    v_exp_f32 v111, v111
    v_fma_f32 v112, v112, s20, v216
    v_fma_f32 v113, v113, s20, v216
    ds_read_b128 v[184:187], v228 offset:8192
    s_waitcnt lgkmcnt(7)
    v_mfma_f32_32x32x16_bf16 v[68:83], v[188:191], v[172:175], v[68:83]
    s_mov_b32 m0, s36
    s_nop 0
    buffer_load_dwordx4 v226, s[16:19], s32 offen offset:1024 lds
    v_fma_f32 v114, v114, s20, v216
    v_fma_f32 v115, v115, s20, v216
    v_exp_f32 v112, v112
    v_exp_f32 v113, v113
    ds_read_b128 v[188:191], v228 offset:1024
    s_waitcnt lgkmcnt(7)
    v_mfma_f32_32x32x16_bf16 v[84:99], v[192:195], v[172:175], v[84:99]
    v_exp_f32 v114, v114
    v_exp_f32 v115, v115
    v_fma_f32 v116, v116, s20, v216
    v_fma_f32 v117, v117, s20, v216
    ds_read_b128 v[192:195], v228 offset:9216
    s_waitcnt lgkmcnt(7)
    v_mfma_f32_32x32x16_bf16 v[36:51], v[196:199], v[176:179], v[36:51]
    s_mov_b32 m0, s36
    s_nop 0
    buffer_load_dwordx4 v226, s[16:19], s32 offen offset:2048 lds
    v_fma_f32 v118, v118, s20, v216
    v_fma_f32 v119, v119, s20, v216
    v_exp_f32 v116, v116
    v_exp_f32 v117, v117
    ds_read_b128 v[196:199], v228 offset:2048
    s_waitcnt lgkmcnt(7)
    v_mfma_f32_32x32x16_bf16 v[52:67], v[200:203], v[176:179], v[52:67]
    v_exp_f32 v118, v118
    v_exp_f32 v119, v119
    v_fma_f32 v120, v120, s20, v216
    v_fma_f32 v121, v121, s20, v216
    ds_read_b128 v[200:203], v228 offset:10240
    s_waitcnt lgkmcnt(7)
    v_mfma_f32_32x32x16_bf16 v[68:83], v[204:207], v[176:179], v[68:83]
    s_mov_b32 m0, s36
    s_nop 0
    buffer_load_dwordx4 v226, s[16:19], s32 offen offset:3072 lds
    v_fma_f32 v122, v122, s20, v216
    v_fma_f32 v123, v123, s20, v216
    v_exp_f32 v120, v120
    v_exp_f32 v121, v121
    ds_read_b128 v[204:207], v228 offset:3072
    s_waitcnt lgkmcnt(7)
    v_mfma_f32_32x32x16_bf16 v[84:99], v[208:211], v[176:179], v[84:99]
    v_exp_f32 v122, v122
    v_exp_f32 v123, v123
    v_fma_f32 v124, v124, s20, v216
    v_fma_f32 v125, v125, s20, v216
    ds_read_b128 v[208:211], v228 offset:11264
    s_waitcnt lgkmcnt(7)
    v_mfma_f32_32x32x16_bf16 v[132:147], v[180:183], v[4:7], 0
    v_fma_f32 v126, v126, s20, v216
    v_fma_f32 v127, v127, s20, v216
    v_exp_f32 v124, v124
    ds_read_b128 v[180:183], v228 offset:4096
    s_waitcnt lgkmcnt(7)
    v_mfma_f32_32x32x16_bf16 v[148:163], v[184:187], v[4:7], 0
    v_exp_f32 v125, v125
    v_exp_f32 v126, v126
    v_exp_f32 v127, v127
    v_fma_f32 v128, v128, s20, v216
    ds_read_b128 v[184:187], v228 offset:12288
    s_waitcnt lgkmcnt(7)
    v_mfma_f32_32x32x16_bf16 v[132:147], v[188:191], v[8:11], v[132:147]
    v_fma_f32 v129, v129, s20, v216
    v_fma_f32 v130, v130, s20, v216
    v_fma_f32 v131, v131, s20, v216
    v_exp_f32 v128, v128
    ds_read_b128 v[188:191], v228 offset:5120
    s_waitcnt lgkmcnt(7)
    v_mfma_f32_32x32x16_bf16 v[148:163], v[192:195], v[8:11], v[148:163]
    v_exp_f32 v129, v129
    v_exp_f32 v130, v130
    v_exp_f32 v131, v131
    v_add_f32 v220, v100, v101
    ds_read_b128 v[192:195], v228 offset:13312
    s_waitcnt lgkmcnt(7)
    v_mfma_f32_32x32x16_bf16 v[132:147], v[196:199], v[12:15], v[132:147]
    v_add_f32 v221, v108, v109
    v_add_f32 v222, v116, v117
    v_add_f32 v223, v124, v125
    v_add_f32 v220, v220, v102
    ds_read_b128 v[196:199], v228 offset:6144
    s_waitcnt lgkmcnt(7)
    v_mfma_f32_32x32x16_bf16 v[148:163], v[200:203], v[12:15], v[148:163]
    v_add_f32 v221, v221, v110
    v_add_f32 v222, v222, v118
    v_add_f32 v223, v223, v126
    v_add_f32 v220, v220, v103
    ds_read_b128 v[200:203], v228 offset:14336
    s_waitcnt lgkmcnt(7)
    v_mfma_f32_32x32x16_bf16 v[132:147], v[204:207], v[16:19], v[132:147]
    v_add_f32 v221, v221, v111
    v_add_f32 v222, v222, v119
    v_add_f32 v223, v223, v127
    v_add_f32 v220, v220, v104
    ds_read_b128 v[204:207], v228 offset:7168
    s_waitcnt lgkmcnt(7)
    v_mfma_f32_32x32x16_bf16 v[148:163], v[208:211], v[16:19], v[148:163]
    v_add_f32 v221, v221, v112
    v_add_f32 v222, v222, v120
    v_add_f32 v223, v223, v128
    v_add_f32 v220, v220, v105
    ds_read_b128 v[208:211], v228 offset:15360
    s_waitcnt lgkmcnt(7)
    v_mfma_f32_32x32x16_bf16 v[132:147], v[180:183], v[20:23], v[132:147]
    v_add_f32 v221, v221, v113
    v_add_f32 v222, v222, v121
    v_add_f32 v223, v223, v129
    s_waitcnt lgkmcnt(6)
    v_mfma_f32_32x32x16_bf16 v[148:163], v[184:187], v[20:23], v[148:163]
    v_add_f32 v220, v220, v106
    v_add_f32 v221, v221, v114
    v_add_f32 v222, v222, v122
    v_add_f32 v223, v223, v130
    s_waitcnt lgkmcnt(5)
    v_mfma_f32_32x32x16_bf16 v[132:147], v[188:191], v[24:27], v[132:147]
    v_add_f32 v220, v220, v107
    v_add_f32 v221, v221, v115
    v_add_f32 v222, v222, v123
    v_add_f32 v223, v223, v131
    s_waitcnt lgkmcnt(4)
    v_mfma_f32_32x32x16_bf16 v[148:163], v[192:195], v[24:27], v[148:163]
    v_add_f32 v220, v220, v221
    v_add_f32 v222, v222, v223
    v_add_f32 v220, v220, v222
    v_add_f32 v213, v213, v220
    s_waitcnt lgkmcnt(3)
    v_mfma_f32_32x32x16_bf16 v[132:147], v[196:199], v[28:31], v[132:147]
    v_cvt_pk_bf16_f32 v164, v100, v101
    v_cvt_pk_bf16_f32 v165, v102, v103
    v_cvt_pk_bf16_f32 v166, v104, v105
    v_cvt_pk_bf16_f32 v167, v106, v107
    s_waitcnt lgkmcnt(2)
    v_mfma_f32_32x32x16_bf16 v[148:163], v[200:203], v[28:31], v[148:163]
    v_cvt_pk_bf16_f32 v168, v108, v109
    v_cvt_pk_bf16_f32 v169, v110, v111
    v_cvt_pk_bf16_f32 v170, v112, v113
    v_cvt_pk_bf16_f32 v171, v114, v115
    s_waitcnt lgkmcnt(1)
    v_mfma_f32_32x32x16_bf16 v[132:147], v[204:207], v[32:35], v[132:147]
    v_cvt_pk_bf16_f32 v172, v116, v117
    v_cvt_pk_bf16_f32 v173, v118, v119
    v_cvt_pk_bf16_f32 v174, v120, v121
    v_cvt_pk_bf16_f32 v175, v122, v123
    s_waitcnt lgkmcnt(0)
    v_mfma_f32_32x32x16_bf16 v[148:163], v[208:211], v[32:35], v[148:163]
    v_cvt_pk_bf16_f32 v176, v124, v125
    v_cvt_pk_bf16_f32 v177, v126, v127
    v_cvt_pk_bf16_f32 v178, v128, v129
    v_cvt_pk_bf16_f32 v179, v130, v131
    s_cmp_eq_u32 s25, 0
    s_cbranch_scc1 attn_noresc_9
    v_pk_mul_f32 v[36:37], v[36:37], v[214:215] op_sel_hi:[1,0]
    v_pk_mul_f32 v[38:39], v[38:39], v[214:215] op_sel_hi:[1,0]
    v_pk_mul_f32 v[40:41], v[40:41], v[214:215] op_sel_hi:[1,0]
    v_pk_mul_f32 v[42:43], v[42:43], v[214:215] op_sel_hi:[1,0]
    v_pk_mul_f32 v[44:45], v[44:45], v[214:215] op_sel_hi:[1,0]
    v_pk_mul_f32 v[46:47], v[46:47], v[214:215] op_sel_hi:[1,0]
    v_pk_mul_f32 v[48:49], v[48:49], v[214:215] op_sel_hi:[1,0]
    v_pk_mul_f32 v[50:51], v[50:51], v[214:215] op_sel_hi:[1,0]
    v_pk_mul_f32 v[52:53], v[52:53], v[214:215] op_sel_hi:[1,0]
    v_pk_mul_f32 v[54:55], v[54:55], v[214:215] op_sel_hi:[1,0]
    v_pk_mul_f32 v[56:57], v[56:57], v[214:215] op_sel_hi:[1,0]
    v_pk_mul_f32 v[58:59], v[58:59], v[214:215] op_sel_hi:[1,0]
    v_pk_mul_f32 v[60:61], v[60:61], v[214:215] op_sel_hi:[1,0]
    v_pk_mul_f32 v[62:63], v[62:63], v[214:215] op_sel_hi:[1,0]
    v_pk_mul_f32 v[64:65], v[64:65], v[214:215] op_sel_hi:[1,0]
    v_pk_mul_f32 v[66:67], v[66:67], v[214:215] op_sel_hi:[1,0]
    v_pk_mul_f32 v[68:69], v[68:69], v[214:215] op_sel_hi:[1,0]
    v_pk_mul_f32 v[70:71], v[70:71], v[214:215] op_sel_hi:[1,0]
    v_pk_mul_f32 v[72:73], v[72:73], v[214:215] op_sel_hi:[1,0]
    v_pk_mul_f32 v[74:75], v[74:75], v[214:215] op_sel_hi:[1,0]
    v_pk_mul_f32 v[76:77], v[76:77], v[214:215] op_sel_hi:[1,0]
    v_pk_mul_f32 v[78:79], v[78:79], v[214:215] op_sel_hi:[1,0]
    v_pk_mul_f32 v[80:81], v[80:81], v[214:215] op_sel_hi:[1,0]
    v_pk_mul_f32 v[82:83], v[82:83], v[214:215] op_sel_hi:[1,0]
    v_pk_mul_f32 v[84:85], v[84:85], v[214:215] op_sel_hi:[1,0]
    v_pk_mul_f32 v[86:87], v[86:87], v[214:215] op_sel_hi:[1,0]
    v_pk_mul_f32 v[88:89], v[88:89], v[214:215] op_sel_hi:[1,0]
    v_pk_mul_f32 v[90:91], v[90:91], v[214:215] op_sel_hi:[1,0]
    v_pk_mul_f32 v[92:93], v[92:93], v[214:215] op_sel_hi:[1,0]
    v_pk_mul_f32 v[94:95], v[94:95], v[214:215] op_sel_hi:[1,0]
    v_pk_mul_f32 v[96:97], v[96:97], v[214:215] op_sel_hi:[1,0]
    v_pk_mul_f32 v[98:99], v[98:99], v[214:215] op_sel_hi:[1,0]
    s_mov_b32 s25, 0
attn_noresc_9:
    s_add_u32 s28, s28, 1
    s_branch attn_loop
attn_last1:
    s_waitcnt vmcnt(0)
    s_barrier
    s_cmp_lg_u32 s33, 0
    s_cselect_b32 s37, s31, s38
    s_cselect_b32 s11, 1, 0
    s_sub_u32 s33, s33, s11
    s_add_u32 s32, s37, 4096
    s_add_u32 s36, s35, 4096
    s_add_u32 s31, s31, 32768
    s_nop 1
    ds_read_b128 v[180:183], v229
    ds_read_b128 v[184:187], v229 offset:1024
    ds_read_b128 v[188:191], v229 offset:2048
    ds_read_b128 v[192:195], v229 offset:3072
    ds_read_b128 v[196:199], v229 offset:4096
    ds_read_b128 v[200:203], v229 offset:5120
    ds_read_b128 v[204:207], v229 offset:6144
    v_cmp_le_i32 s[44:45], 0, v225
    v_cmp_le_i32 s[46:47], 1, v225
    v_cmp_le_i32 s[48:49], 2, v225
    v_cmp_le_i32 s[50:51], 3, v225
    v_cndmask_b32 v132, v224, v132, s[44:45]
    v_cndmask_b32 v133, v224, v133, s[46:47]
    v_cndmask_b32 v134, v224, v134, s[48:49]
    v_cndmask_b32 v135, v224, v135, s[50:51]
    v_cmp_le_i32 s[44:45], 8, v225
    v_cmp_le_i32 s[46:47], 9, v225
    ds_read_b128 v[208:211], v229 offset:7168
    s_waitcnt lgkmcnt(7)
    v_mfma_f32_32x32x16_bf16 v[36:51], v[180:183], v[164:167], v[36:51]
    s_mov_b32 m0, s35
    s_nop 0
    buffer_load_dwordx4 v226, s[16:19], s37 offen lds
    v_cmp_le_i32 s[48:49], 10, v225
    v_cmp_le_i32 s[50:51], 11, v225
    v_cndmask_b32 v136, v224, v136, s[44:45]
    v_cndmask_b32 v137, v224, v137, s[46:47]
    v_cndmask_b32 v138, v224, v138, s[48:49]
    v_cndmask_b32 v139, v224, v139, s[50:51]
    v_cmp_le_i32 s[44:45], 16, v225
    v_cmp_le_i32 s[46:47], 17, v225
    v_cmp_le_i32 s[48:49], 18, v225
    v_cmp_le_i32 s[50:51], 19, v225
    v_cndmask_b32 v140, v224, v140, s[44:45]
    ds_read_b128 v[180:183], v229 offset:8192
    s_waitcnt lgkmcnt(7)
    v_mfma_f32_32x32x16_bf16 v[52:67], v[184:187], v[164:167], v[52:67]
    v_cndmask_b32 v141, v224, v141, s[46:47]
    v_cndmask_b32 v142, v224, v142, s[48:49]
    v_cndmask_b32 v143, v224, v143, s[50:51]
    v_cmp_le_i32 s[44:45], 24, v225
    v_cmp_le_i32 s[46:47], 25, v225
    v_cmp_le_i32 s[48:49], 26, v225
    v_cmp_le_i32 s[50:51], 27, v225
    v_cndmask_b32 v144, v224, v144, s[44:45]
    v_cndmask_b32 v145, v224, v145, s[46:47]
    v_cndmask_b32 v146, v224, v146, s[48:49]
    v_cndmask_b32 v147, v224, v147, s[50:51]
    v_cmp_le_i32 s[44:45], 32, v225
    ds_read_b128 v[184:187], v229 offset:9216
    s_waitcnt lgkmcnt(7)
    v_mfma_f32_32x32x16_bf16 v[68:83], v[188:191], v[164:167], v[68:83]
    s_mov_b32 m0, s35
    s_nop 0
    buffer_load_dwordx4 v226, s[16:19], s37 offen offset:1024 lds
    v_cmp_le_i32 s[46:47], 33, v225
    v_cmp_le_i32 s[48:49], 34, v225
    v_cmp_le_i32 s[50:51], 35, v225
    v_cndmask_b32 v148, v224, v148, s[44:45]
    v_cndmask_b32 v149, v224, v149, s[46:47]
    v_cndmask_b32 v150, v224, v150, s[48:49]
    v_cndmask_b32 v151, v224, v151, s[50:51]
    v_cmp_le_i32 s[44:45], 40, v225
    v_cmp_le_i32 s[46:47], 41, v225
    v_cmp_le_i32 s[48:49], 42, v225
    v_cmp_le_i32 s[50:51], 43, v225
    v_cndmask_b32 v152, v224, v152, s[44:45]
    ds_read_b128 v[188:191], v229 offset:10240
    s_waitcnt lgkmcnt(7)
    v_mfma_f32_32x32x16_bf16 v[84:99], v[192:195], v[164:167], v[84:99]
    v_cndmask_b32 v153, v224, v153, s[46:47]
    v_cndmask_b32 v154, v224, v154, s[48:49]
    v_cndmask_b32 v155, v224, v155, s[50:51]
    v_cmp_le_i32 s[44:45], 48, v225
    v_cmp_le_i32 s[46:47], 49, v225
    v_cmp_le_i32 s[48:49], 50, v225
    v_cmp_le_i32 s[50:51], 51, v225
    v_cndmask_b32 v156, v224, v156, s[44:45]
    v_cndmask_b32 v157, v224, v157, s[46:47]
    v_cndmask_b32 v158, v224, v158, s[48:49]
    v_cndmask_b32 v159, v224, v159, s[50:51]
    v_cmp_le_i32 s[44:45], 56, v225
    ds_read_b128 v[192:195], v229 offset:11264
    s_waitcnt lgkmcnt(7)
    v_mfma_f32_32x32x16_bf16 v[36:51], v[196:199], v[168:171], v[36:51]
    s_mov_b32 m0, s35
    s_nop 0
    buffer_load_dwordx4 v226, s[16:19], s37 offen offset:2048 lds
    v_cmp_le_i32 s[46:47], 57, v225
    v_cmp_le_i32 s[48:49], 58, v225
    v_cmp_le_i32 s[50:51], 59, v225
    v_cndmask_b32 v160, v224, v160, s[44:45]
    v_cndmask_b32 v161, v224, v161, s[46:47]
    v_cndmask_b32 v162, v224, v162, s[48:49]
    v_cndmask_b32 v163, v224, v163, s[50:51]
    v_max3_f32 v220, v132, v133, v134
    v_max3_f32 v221, v140, v141, v142
    v_max3_f32 v222, v148, v149, v150
    v_max3_f32 v223, v156, v157, v158
    ds_read_b128 v[196:199], v229 offset:12288
    s_waitcnt lgkmcnt(7)
    v_mfma_f32_32x32x16_bf16 v[52:67], v[200:203], v[168:171], v[52:67]
    v_max3_f32 v220, v220, v135, v136
    v_max3_f32 v221, v221, v143, v144
    v_max3_f32 v222, v222, v151, v152
    v_max3_f32 v223, v223, v159, v160
    v_max3_f32 v220, v220, v137, v138
    v_max3_f32 v221, v221, v145, v146
    v_max3_f32 v222, v222, v153, v154
    v_max3_f32 v223, v223, v161, v162
    v_max_f32 v220, v220, v139
    v_max_f32 v221, v221, v147
    v_max_f32 v222, v222, v155
    v_max_f32 v223, v223, v163
    ds_read_b128 v[200:203], v229 offset:13312
    s_waitcnt lgkmcnt(7)
    v_mfma_f32_32x32x16_bf16 v[68:83], v[204:207], v[168:171], v[68:83]
    s_mov_b32 m0, s35
    s_nop 0
    buffer_load_dwordx4 v226, s[16:19], s37 offen offset:3072 lds
    v_max3_f32 v220, v220, v221, v222
    v_max_f32 v220, v220, v223
    v_mov_b32 v221, v220
    s_nop 1
    v_permlane32_swap_b32 v220, v221
    v_max_f32 v220, v220, v221
    v_sub_f32 v221, v220, v212
    v_cmp_lt_f32 vcc, s24, v221
    s_cbranch_vccnz attn_rare_10
attn_back_11:
    v_fma_f32 v132, v132, s20, v216
    v_fma_f32 v133, v133, s20, v216
    v_fma_f32 v134, v134, s20, v216
    v_fma_f32 v135, v135, s20, v216
    v_exp_f32 v132, v132
    v_exp_f32 v133, v133
    ds_read_b128 v[204:207], v229 offset:14336
    s_waitcnt lgkmcnt(7)
    v_mfma_f32_32x32x16_bf16 v[84:99], v[208:211], v[168:171], v[84:99]
    v_exp_f32 v134, v134
    v_exp_f32 v135, v135
    v_fma_f32 v136, v136, s20, v216
    v_fma_f32 v137, v137, s20, v216
    v_fma_f32 v138, v138, s20, v216
    v_fma_f32 v139, v139, s20, v216
    v_exp_f32 v136, v136
    v_exp_f32 v137, v137
    v_exp_f32 v138, v138
    v_exp_f32 v139, v139
    v_fma_f32 v140, v140, s20, v216
    v_fma_f32 v141, v141, s20, v216
    ds_read_b128 v[208:211], v229 offset:15360
    s_waitcnt lgkmcnt(7)
    v_mfma_f32_32x32x16_bf16 v[36:51], v[180:183], v[172:175], v[36:51]
    s_mov_b32 m0, s36
    s_nop 0
    buffer_load_dwordx4 v226, s[16:19], s32 offen lds
    v_fma_f32 v142, v142, s20, v216
    v_fma_f32 v143, v143, s20, v216
    v_exp_f32 v140, v140
    v_exp_f32 v141, v141
    v_exp_f32 v142, v142
    v_exp_f32 v143, v143
    v_fma_f32 v144, v144, s20, v216
    v_fma_f32 v145, v145, s20, v216
    v_fma_f32 v146, v146, s20, v216
    v_fma_f32 v147, v147, s20, v216
    v_exp_f32 v144, v144
    s_waitcnt lgkmcnt(6)
    v_mfma_f32_32x32x16_bf16 v[52:67], v[184:187], v[172:175], v[52:67]
    v_exp_f32 v145, v145
    v_exp_f32 v146, v146
    v_exp_f32 v147, v147
    v_fma_f32 v148, v148, s20, v216
    v_fma_f32 v149, v149, s20, v216
    v_fma_f32 v150, v150, s20, v216
    v_fma_f32 v151, v151, s20, v216
    v_exp_f32 v148, v148
    v_exp_f32 v149, v149
    v_exp_f32 v150, v150
    v_exp_f32 v151, v151
    v_fma_f32 v152, v152, s20, v216
    s_waitcnt lgkmcnt(5)
    v_mfma_f32_32x32x16_bf16 v[68:83], v[188:191], v[172:175], v[68:83]
    s_mov_b32 m0, s36
    s_nop 0
    buffer_load_dwordx4 v226, s[16:19], s32 offen offset:1024 lds
    v_fma_f32 v153, v153, s20, v216
    v_fma_f32 v154, v154, s20, v216
    v_fma_f32 v155, v155, s20, v216
    v_exp_f32 v152, v152
    v_exp_f32 v153, v153
    v_exp_f32 v154, v154
    v_exp_f32 v155, v155
    v_fma_f32 v156, v156, s20, v216
    v_fma_f32 v157, v157, s20, v216
    v_fma_f32 v158, v158, s20, v216
    v_fma_f32 v159, v159, s20, v216
    v_exp_f32 v156, v156
    s_waitcnt lgkmcnt(4)
    v_mfma_f32_32x32x16_bf16 v[84:99], v[192:195], v[172:175], v[84:99]
    v_exp_f32 v157, v157
    v_exp_f32 v158, v158
    v_exp_f32 v159, v159
    v_fma_f32 v160, v160, s20, v216
    v_fma_f32 v161, v161, s20, v216
    v_fma_f32 v162, v162, s20, v216
    v_fma_f32 v163, v163, s20, v216
    v_exp_f32 v160, v160
    v_exp_f32 v161, v161
    v_exp_f32 v162, v162
    v_exp_f32 v163, v163
    v_add_f32 v220, v132, v133
    s_waitcnt lgkmcnt(3)
    v_mfma_f32_32x32x16_bf16 v[36:51], v[196:199], v[176:179], v[36:51]
    s_mov_b32 m0, s36
    s_nop 0
    buffer_load_dwordx4 v226, s[16:19], s32 offen offset:2048 lds
    v_add_f32 v221, v140, v141
    v_add_f32 v222, v148, v149
    v_add_f32 v223, v156, v157
    v_add_f32 v220, v220, v134
    v_add_f32 v221, v221, v142
    v_add_f32 v222, v222, v150
    v_add_f32 v223, v223, v158
    v_add_f32 v220, v220, v135
    v_add_f32 v221, v221, v143
    v_add_f32 v222, v222, v151
    v_add_f32 v223, v223, v159
    s_waitcnt lgkmcnt(2)
    v_mfma_f32_32x32x16_bf16 v[52:67], v[200:203], v[176:179], v[52:67]
    v_add_f32 v220, v220, v136
    v_add_f32 v221, v221, v144
    v_add_f32 v222, v222, v152
    v_add_f32 v223, v223, v160
    v_add_f32 v220, v220, v137
    v_add_f32 v221, v221, v145
    v_add_f32 v222, v222, v153
    v_add_f32 v223, v223, v161
    v_add_f32 v220, v220, v138
    v_add_f32 v221, v221, v146
    v_add_f32 v222, v222, v154
    v_add_f32 v223, v223, v162
    s_waitcnt lgkmcnt(1)
    v_mfma_f32_32x32x16_bf16 v[68:83], v[204:207], v[176:179], v[68:83]
    s_mov_b32 m0, s36
    s_nop 0
    buffer_load_dwordx4 v226, s[16:19], s32 offen offset:3072 lds
    v_add_f32 v220, v220, v139
    v_add_f32 v221, v221, v147
    v_add_f32 v222, v222, v155
    v_add_f32 v223, v223, v163
    v_add_f32 v220, v220, v221
    v_add_f32 v222, v222, v223
    v_add_f32 v220, v220, v222
    v_add_f32 v213, v213, v220
    s_waitcnt lgkmcnt(0)
    v_mfma_f32_32x32x16_bf16 v[84:99], v[208:211], v[176:179], v[84:99]
    v_cvt_pk_bf16_f32 v164, v132, v133
    v_cvt_pk_bf16_f32 v165, v134, v135
    v_cvt_pk_bf16_f32 v166, v136, v137
    v_cvt_pk_bf16_f32 v167, v138, v139
    v_cvt_pk_bf16_f32 v168, v140, v141
    v_cvt_pk_bf16_f32 v169, v142, v143
    v_cvt_pk_bf16_f32 v170, v144, v145
    v_cvt_pk_bf16_f32 v171, v146, v147
    v_cvt_pk_bf16_f32 v172, v148, v149
    v_cvt_pk_bf16_f32 v173, v150, v151
    v_cvt_pk_bf16_f32 v174, v152, v153
    v_cvt_pk_bf16_f32 v175, v154, v155
    v_cvt_pk_bf16_f32 v176, v156, v157
    v_cvt_pk_bf16_f32 v177, v158, v159
    v_cvt_pk_bf16_f32 v178, v160, v161
    v_cvt_pk_bf16_f32 v179, v162, v163
    s_cmp_eq_u32 s25, 0
    s_cbranch_scc1 attn_noresc_12
    v_pk_mul_f32 v[36:37], v[36:37], v[214:215] op_sel_hi:[1,0]
    v_pk_mul_f32 v[38:39], v[38:39], v[214:215] op_sel_hi:[1,0]
    v_pk_mul_f32 v[40:41], v[40:41], v[214:215] op_sel_hi:[1,0]
    v_pk_mul_f32 v[42:43], v[42:43], v[214:215] op_sel_hi:[1,0]
    v_pk_mul_f32 v[44:45], v[44:45], v[214:215] op_sel_hi:[1,0]
    v_pk_mul_f32 v[46:47], v[46:47], v[214:215] op_sel_hi:[1,0]
    v_pk_mul_f32 v[48:49], v[48:49], v[214:215] op_sel_hi:[1,0]
    v_pk_mul_f32 v[50:51], v[50:51], v[214:215] op_sel_hi:[1,0]
    v_pk_mul_f32 v[52:53], v[52:53], v[214:215] op_sel_hi:[1,0]
    v_pk_mul_f32 v[54:55], v[54:55], v[214:215] op_sel_hi:[1,0]
    v_pk_mul_f32 v[56:57], v[56:57], v[214:215] op_sel_hi:[1,0]
    v_pk_mul_f32 v[58:59], v[58:59], v[214:215] op_sel_hi:[1,0]
    v_pk_mul_f32 v[60:61], v[60:61], v[214:215] op_sel_hi:[1,0]
    v_pk_mul_f32 v[62:63], v[62:63], v[214:215] op_sel_hi:[1,0]
    v_pk_mul_f32 v[64:65], v[64:65], v[214:215] op_sel_hi:[1,0]
    v_pk_mul_f32 v[66:67], v[66:67], v[214:215] op_sel_hi:[1,0]
    v_pk_mul_f32 v[68:69], v[68:69], v[214:215] op_sel_hi:[1,0]
    v_pk_mul_f32 v[70:71], v[70:71], v[214:215] op_sel_hi:[1,0]
    v_pk_mul_f32 v[72:73], v[72:73], v[214:215] op_sel_hi:[1,0]
    v_pk_mul_f32 v[74:75], v[74:75], v[214:215] op_sel_hi:[1,0]
    v_pk_mul_f32 v[76:77], v[76:77], v[214:215] op_sel_hi:[1,0]
    v_pk_mul_f32 v[78:79], v[78:79], v[214:215] op_sel_hi:[1,0]
    v_pk_mul_f32 v[80:81], v[80:81], v[214:215] op_sel_hi:[1,0]
    v_pk_mul_f32 v[82:83], v[82:83], v[214:215] op_sel_hi:[1,0]
    v_pk_mul_f32 v[84:85], v[84:85], v[214:215] op_sel_hi:[1,0]
    v_pk_mul_f32 v[86:87], v[86:87], v[214:215] op_sel_hi:[1,0]
    v_pk_mul_f32 v[88:89], v[88:89], v[214:215] op_sel_hi:[1,0]
    v_pk_mul_f32 v[90:91], v[90:91], v[214:215] op_sel_hi:[1,0]
    v_pk_mul_f32 v[92:93], v[92:93], v[214:215] op_sel_hi:[1,0]
    v_pk_mul_f32 v[94:95], v[94:95], v[214:215] op_sel_hi:[1,0]
    v_pk_mul_f32 v[96:97], v[96:97], v[214:215] op_sel_hi:[1,0]
    v_pk_mul_f32 v[98:99], v[98:99], v[214:215] op_sel_hi:[1,0]
    s_mov_b32 s25, 0
attn_noresc_12:
    s_waitcnt vmcnt(0)
    s_barrier
    ds_read_b128 v[180:183], v230
    ds_read_b128 v[184:187], v230 offset:1024
    ds_read_b128 v[188:191], v230 offset:2048
    ds_read_b128 v[192:195], v230 offset:3072
    ds_read_b128 v[196:199], v230 offset:4096
    ds_read_b128 v[200:203], v230 offset:5120
    ds_read_b128 v[204:207], v230 offset:6144
    ds_read_b128 v[208:211], v230 offset:7168
    s_waitcnt lgkmcnt(7)
    v_mfma_f32_32x32x16_bf16 v[36:51], v[180:183], v[164:167], v[36:51]
    ds_read_b128 v[180:183], v230 offset:8192
    s_waitcnt lgkmcnt(7)
    v_mfma_f32_32x32x16_bf16 v[52:67], v[184:187], v[164:167], v[52:67]
    ds_read_b128 v[184:187], v230 offset:9216
    s_waitcnt lgkmcnt(7)
    v_mfma_f32_32x32x16_bf16 v[68:83], v[188:191], v[164:167], v[68:83]
    ds_read_b128 v[188:191], v230 offset:10240
    s_waitcnt lgkmcnt(7)
    v_mfma_f32_32x32x16_bf16 v[84:99], v[192:195], v[164:167], v[84:99]
    ds_read_b128 v[192:195], v230 offset:11264
    s_waitcnt lgkmcnt(7)
    v_mfma_f32_32x32x16_bf16 v[36:51], v[196:199], v[168:171], v[36:51]
    ds_read_b128 v[196:199], v230 offset:12288
    s_waitcnt lgkmcnt(7)
    v_mfma_f32_32x32x16_bf16 v[52:67], v[200:203], v[168:171], v[52:67]
    ds_read_b128 v[200:203], v230 offset:13312
    s_waitcnt lgkmcnt(7)
    v_mfma_f32_32x32x16_bf16 v[68:83], v[204:207], v[168:171], v[68:83]
    ds_read_b128 v[204:207], v230 offset:14336
    s_waitcnt lgkmcnt(7)
    v_mfma_f32_32x32x16_bf16 v[84:99], v[208:211], v[168:171], v[84:99]
    ds_read_b128 v[208:211], v230 offset:15360
    s_waitcnt lgkmcnt(7)
    v_mfma_f32_32x32x16_bf16 v[36:51], v[180:183], v[172:175], v[36:51]
    s_waitcnt lgkmcnt(6)
    v_mfma_f32_32x32x16_bf16 v[52:67], v[184:187], v[172:175], v[52:67]
    s_waitcnt lgkmcnt(5)
    v_mfma_f32_32x32x16_bf16 v[68:83], v[188:191], v[172:175], v[68:83]
    s_waitcnt lgkmcnt(4)
    v_mfma_f32_32x32x16_bf16 v[84:99], v[192:195], v[172:175], v[84:99]
    s_waitcnt lgkmcnt(3)
    v_mfma_f32_32x32x16_bf16 v[36:51], v[196:199], v[176:179], v[36:51]
    s_waitcnt lgkmcnt(2)
    v_mfma_f32_32x32x16_bf16 v[52:67], v[200:203], v[176:179], v[52:67]
    s_waitcnt lgkmcnt(1)
    v_mfma_f32_32x32x16_bf16 v[68:83], v[204:207], v[176:179], v[68:83]
    s_waitcnt lgkmcnt(0)
    v_mfma_f32_32x32x16_bf16 v[84:99], v[208:211], v[176:179], v[84:99]
    s_branch attn_merge
attn_last0:
    s_waitcnt vmcnt(0)
    s_barrier
    s_cmp_lg_u32 s33, 0
    s_cselect_b32 s37, s31, s38
    s_cselect_b32 s11, 1, 0
    s_sub_u32 s33, s33, s11
    s_add_u32 s32, s37, 4096
    s_add_u32 s36, s34, 4096
    s_add_u32 s31, s31, 32768
    s_nop 1
    ds_read_b128 v[180:183], v230
    ds_read_b128 v[184:187], v230 offset:1024
    ds_read_b128 v[188:191], v230 offset:2048
    ds_read_b128 v[192:195], v230 offset:3072
    ds_read_b128 v[196:199], v230 offset:4096
    ds_read_b128 v[200:203], v230 offset:5120
    ds_read_b128 v[204:207], v230 offset:6144
    v_cmp_le_i32 s[44:45], 0, v225
    v_cmp_le_i32 s[46:47], 1, v225
    v_cmp_le_i32 s[48:49], 2, v225
    v_cmp_le_i32 s[50:51], 3, v225
    v_cndmask_b32 v100, v224, v100, s[44:45]
    v_cndmask_b32 v101, v224, v101, s[46:47]
    v_cndmask_b32 v102, v224, v102, s[48:49]
    v_cndmask_b32 v103, v224, v103, s[50:51]
    v_cmp_le_i32 s[44:45], 8, v225
    v_cmp_le_i32 s[46:47], 9, v225
    ds_read_b128 v[208:211], v230 offset:7168
    s_waitcnt lgkmcnt(7)
    v_mfma_f32_32x32x16_bf16 v[36:51], v[180:183], v[164:167], v[36:51]
    s_mov_b32 m0, s34
    s_nop 0
    buffer_load_dwordx4 v226, s[16:19], s37 offen lds
    v_cmp_le_i32 s[48:49], 10, v225
    v_cmp_le_i32 s[50:51], 11, v225
    v_cndmask_b32 v104, v224, v104, s[44:45]
    v_cndmask_b32 v105, v224, v105, s[46:47]
    v_cndmask_b32 v106, v224, v106, s[48:49]
    v_cndmask_b32 v107, v224, v107, s[50:51]
    v_cmp_le_i32 s[44:45], 16, v225
    v_cmp_le_i32 s[46:47], 17, v225
    v_cmp_le_i32 s[48:49], 18, v225
    v_cmp_le_i32 s[50:51], 19, v225
    v_cndmask_b32 v108, v224, v108, s[44:45]
    ds_read_b128 v[180:183], v230 offset:8192
    s_waitcnt lgkmcnt(7)
    v_mfma_f32_32x32x16_bf16 v[52:67], v[184:187], v[164:167], v[52:67]
    v_cndmask_b32 v109, v224, v109, s[46:47]
    v_cndmask_b32 v110, v224, v110, s[48:49]
    v_cndmask_b32 v111, v224, v111, s[50:51]
    v_cmp_le_i32 s[44:45], 24, v225
    v_cmp_le_i32 s[46:47], 25, v225
    v_cmp_le_i32 s[48:49], 26, v225
    v_cmp_le_i32 s[50:51], 27, v225
    v_cndmask_b32 v112, v224, v112, s[44:45]
    v_cndmask_b32 v113, v224, v113, s[46:47]
    v_cndmask_b32 v114, v224, v114, s[48:49]
    v_cndmask_b32 v115, v224, v115, s[50:51]
    v_cmp_le_i32 s[44:45], 32, v225
    ds_read_b128 v[184:187], v230 offset:9216
    s_waitcnt lgkmcnt(7)
    v_mfma_f32_32x32x16_bf16 v[68:83], v[188:191], v[164:167], v[68:83]
    s_mov_b32 m0, s34
    s_nop 0
    buffer_load_dwordx4 v226, s[16:19], s37 offen offset:1024 lds
    v_cmp_le_i32 s[46:47], 33, v225
    v_cmp_le_i32 s[48:49], 34, v225
    v_cmp_le_i32 s[50:51], 35, v225
    v_cndmask_b32 v116, v224, v116, s[44:45]
    v_cndmask_b32 v117, v224, v117, s[46:47]
    v_cndmask_b32 v118, v224, v118, s[48:49]
    v_cndmask_b32 v119, v224, v119, s[50:51]
    v_cmp_le_i32 s[44:45], 40, v225
    v_cmp_le_i32 s[46:47], 41, v225
    v_cmp_le_i32 s[48:49], 42, v225
    v_cmp_le_i32 s[50:51], 43, v225
    v_cndmask_b32 v120, v224, v120, s[44:45]
    ds_read_b128 v[188:191], v230 offset:10240
    s_waitcnt lgkmcnt(7)
    v_mfma_f32_32x32x16_bf16 v[84:99], v[192:195], v[164:167], v[84:99]
    v_cndmask_b32 v121, v224, v121, s[46:47]
    v_cndmask_b32 v122, v224, v122, s[48:49]
    v_cndmask_b32 v123, v224, v123, s[50:51]
    v_cmp_le_i32 s[44:45], 48, v225
    v_cmp_le_i32 s[46:47], 49, v225
    v_cmp_le_i32 s[48:49], 50, v225
    v_cmp_le_i32 s[50:51], 51, v225
    v_cndmask_b32 v124, v224, v124, s[44:45]
    v_cndmask_b32 v125, v224, v125, s[46:47]
    v_cndmask_b32 v126, v224, v126, s[48:49]
    v_cndmask_b32 v127, v224, v127, s[50:51]
    v_cmp_le_i32 s[44:45], 56, v225
    ds_read_b128 v[192:195], v230 offset:11264
    s_waitcnt lgkmcnt(7)
    v_mfma_f32_32x32x16_bf16 v[36:51], v[196:199], v[168:171], v[36:51]
    s_mov_b32 m0, s34
    s_nop 0
    buffer_load_dwordx4 v226, s[16:19], s37 offen offset:2048 lds
    v_cmp_le_i32 s[46:47], 57, v225
    v_cmp_le_i32 s[48:49], 58, v225
    v_cmp_le_i32 s[50:51], 59, v225
    v_cndmask_b32 v128, v224, v128, s[44:45]
    v_cndmask_b32 v129, v224, v129, s[46:47]
    v_cndmask_b32 v130, v224, v130, s[48:49]
    v_cndmask_b32 v131, v224, v131, s[50:51]
    v_max3_f32 v220, v100, v101, v102
    v_max3_f32 v221, v108, v109, v110
    v_max3_f32 v222, v116, v117, v118
    v_max3_f32 v223, v124, v125, v126
    ds_read_b128 v[196:199], v230 offset:12288
    s_waitcnt lgkmcnt(7)
    v_mfma_f32_32x32x16_bf16 v[52:67], v[200:203], v[168:171], v[52:67]
    v_max3_f32 v220, v220, v103, v104
    v_max3_f32 v221, v221, v111, v112
    v_max3_f32 v222, v222, v119, v120
    v_max3_f32 v223, v223, v127, v128
    v_max3_f32 v220, v220, v105, v106
    v_max3_f32 v221, v221, v113, v114
    v_max3_f32 v222, v222, v121, v122
    v_max3_f32 v223, v223, v129, v130
    v_max_f32 v220, v220, v107
    v_max_f32 v221, v221, v115
    v_max_f32 v222, v222, v123
    v_max_f32 v223, v223, v131
    ds_read_b128 v[200:203], v230 offset:13312
    s_waitcnt lgkmcnt(7)
    v_mfma_f32_32x32x16_bf16 v[68:83], v[204:207], v[168:171], v[68:83]
    s_mov_b32 m0, s34
    s_nop 0
    buffer_load_dwordx4 v226, s[16:19], s37 offen offset:3072 lds
    v_max3_f32 v220, v220, v221, v222
    v_max_f32 v220, v220, v223
    v_mov_b32 v221, v220
    s_nop 1
    v_permlane32_swap_b32 v220, v221
    v_max_f32 v220, v220, v221
    v_sub_f32 v221, v220, v212
    v_cmp_lt_f32 vcc, s24, v221
    s_cbranch_vccnz attn_rare_13
attn_back_14:
    v_fma_f32 v100, v100, s20, v216
    v_fma_f32 v101, v101, s20, v216
    v_fma_f32 v102, v102, s20, v216
    v_fma_f32 v103, v103, s20, v216
    v_exp_f32 v100, v100
    v_exp_f32 v101, v101
    ds_read_b128 v[204:207], v230 offset:14336
    s_waitcnt lgkmcnt(7)
    v_mfma_f32_32x32x16_bf16 v[84:99], v[208:211], v[168:171], v[84:99]
    v_exp_f32 v102, v102
    v_exp_f32 v103, v103
    v_fma_f32 v104, v104, s20, v216
    v_fma_f32 v105, v105, s20, v216
    v_fma_f32 v106, v106, s20, v216
    v_fma_f32 v107, v107, s20, v216
    v_exp_f32 v104, v104
    v_exp_f32 v105, v105
    v_exp_f32 v106, v106
    v_exp_f32 v107, v107
    v_fma_f32 v108, v108, s20, v216
    v_fma_f32 v109, v109, s20, v216
    ds_read_b128 v[208:211], v230 offset:15360
    s_waitcnt lgkmcnt(7)
    v_mfma_f32_32x32x16_bf16 v[36:51], v[180:183], v[172:175], v[36:51]
    s_mov_b32 m0, s36
    s_nop 0
    buffer_load_dwordx4 v226, s[16:19], s32 offen lds
    v_fma_f32 v110, v110, s20, v216
    v_fma_f32 v111, v111, s20, v216
    v_exp_f32 v108, v108
    v_exp_f32 v109, v109
    v_exp_f32 v110, v110
    v_exp_f32 v111, v111
    v_fma_f32 v112, v112, s20, v216
    v_fma_f32 v113, v113, s20, v216
    v_fma_f32 v114, v114, s20, v216
    v_fma_f32 v115, v115, s20, v216
    v_exp_f32 v112, v112
    s_waitcnt lgkmcnt(6)
    v_mfma_f32_32x32x16_bf16 v[52:67], v[184:187], v[172:175], v[52:67]
    v_exp_f32 v113, v113
    v_exp_f32 v114, v114
    v_exp_f32 v115, v115
    v_fma_f32 v116, v116, s20, v216
    v_fma_f32 v117, v117, s20, v216
    v_fma_f32 v118, v118, s20, v216
    v_fma_f32 v119, v119, s20, v216
    v_exp_f32 v116, v116
    v_exp_f32 v117, v117
    v_exp_f32 v118, v118
    v_exp_f32 v119, v119
    v_fma_f32 v120, v120, s20, v216
    s_waitcnt lgkmcnt(5)
    v_mfma_f32_32x32x16_bf16 v[68:83], v[188:191], v[172:175], v[68:83]
    s_mov_b32 m0, s36
    s_nop 0
    buffer_load_dwordx4 v226, s[16:19], s32 offen offset:1024 lds
    v_fma_f32 v121, v121, s20, v216
    v_fma_f32 v122, v122, s20, v216
    v_fma_f32 v123, v123, s20, v216
    v_exp_f32 v120, v120
    v_exp_f32 v121, v121
    v_exp_f32 v122, v122
    v_exp_f32 v123, v123
    v_fma_f32 v124, v124, s20, v216
    v_fma_f32 v125, v125, s20, v216
    v_fma_f32 v126, v126, s20, v216
    v_fma_f32 v127, v127, s20, v216
    v_exp_f32 v124, v124
    s_waitcnt lgkmcnt(4)
    v_mfma_f32_32x32x16_bf16 v[84:99], v[192:195], v[172:175], v[84:99]
    v_exp_f32 v125, v125
    v_exp_f32 v126, v126
    v_exp_f32 v127, v127
    v_fma_f32 v128, v128, s20, v216
    v_fma_f32 v129, v129, s20, v216
    v_fma_f32 v130, v130, s20, v216
    v_fma_f32 v131, v131, s20, v216
    v_exp_f32 v128, v128
    v_exp_f32 v129, v129
    v_exp_f32 v130, v130
    v_exp_f32 v131, v131
    v_add_f32 v220, v100, v101
    s_waitcnt lgkmcnt(3)
    v_mfma_f32_32x32x16_bf16 v[36:51], v[196:199], v[176:179], v[36:51]
    s_mov_b32 m0, s36
    s_nop 0
    buffer_load_dwordx4 v226, s[16:19], s32 offen offset:2048 lds
    v_add_f32 v221, v108, v109
    v_add_f32 v222, v116, v117
    v_add_f32 v223, v124, v125
    v_add_f32 v220, v220, v102
    v_add_f32 v221, v221, v110
    v_add_f32 v222, v222, v118
    v_add_f32 v223, v223, v126
    v_add_f32 v220, v220, v103
    v_add_f32 v221, v221, v111
    v_add_f32 v222, v222, v119
    v_add_f32 v223, v223, v127
    s_waitcnt lgkmcnt(2)
    v_mfma_f32_32x32x16_bf16 v[52:67], v[200:203], v[176:179], v[52:67]
    v_add_f32 v220, v220, v104
    v_add_f32 v221, v221, v112
    v_add_f32 v222, v222, v120
    v_add_f32 v223, v223, v128
    v_add_f32 v220, v220, v105
    v_add_f32 v221, v221, v113
    v_add_f32 v222, v222, v121
    v_add_f32 v223, v223, v129
    v_add_f32 v220, v220, v106
    v_add_f32 v221, v221, v114
    v_add_f32 v222, v222, v122
    v_add_f32 v223, v223, v130
    s_waitcnt lgkmcnt(1)
    v_mfma_f32_32x32x16_bf16 v[68:83], v[204:207], v[176:179], v[68:83]
    s_mov_b32 m0, s36
    s_nop 0
    buffer_load_dwordx4 v226, s[16:19], s32 offen offset:3072 lds
    v_add_f32 v220, v220, v107
    v_add_f32 v221, v221, v115
    v_add_f32 v222, v222, v123
    v_add_f32 v223, v223, v131
    v_add_f32 v220, v220, v221
    v_add_f32 v222, v222, v223
    v_add_f32 v220, v220, v222
    v_add_f32 v213, v213, v220
    s_waitcnt lgkmcnt(0)
    v_mfma_f32_32x32x16_bf16 v[84:99], v[208:211], v[176:179], v[84:99]
    v_cvt_pk_bf16_f32 v164, v100, v101
    v_cvt_pk_bf16_f32 v165, v102, v103
    v_cvt_pk_bf16_f32 v166, v104, v105
    v_cvt_pk_bf16_f32 v167, v106, v107
    v_cvt_pk_bf16_f32 v168, v108, v109
    v_cvt_pk_bf16_f32 v169, v110, v111
    v_cvt_pk_bf16_f32 v170, v112, v113
    v_cvt_pk_bf16_f32 v171, v114, v115
    v_cvt_pk_bf16_f32 v172, v116, v117
    v_cvt_pk_bf16_f32 v173, v118, v119
    v_cvt_pk_bf16_f32 v174, v120, v121
    v_cvt_pk_bf16_f32 v175, v122, v123
    v_cvt_pk_bf16_f32 v176, v124, v125
    v_cvt_pk_bf16_f32 v177, v126, v127
    v_cvt_pk_bf16_f32 v178, v128, v129
    v_cvt_pk_bf16_f32 v179, v130, v131
    s_cmp_eq_u32 s25, 0
    s_cbranch_scc1 attn_noresc_15
    v_pk_mul_f32 v[36:37], v[36:37], v[214:215] op_sel_hi:[1,0]
    v_pk_mul_f32 v[38:39], v[38:39], v[214:215] op_sel_hi:[1,0]
    v_pk_mul_f32 v[40:41], v[40:41], v[214:215] op_sel_hi:[1,0]
    v_pk_mul_f32 v[42:43], v[42:43], v[214:215] op_sel_hi:[1,0]
    v_pk_mul_f32 v[44:45], v[44:45], v[214:215] op_sel_hi:[1,0]
    v_pk_mul_f32 v[46:47], v[46:47], v[214:215] op_sel_hi:[1,0]
    v_pk_mul_f32 v[48:49], v[48:49], v[214:215] op_sel_hi:[1,0]
    v_pk_mul_f32 v[50:51], v[50:51], v[214:215] op_sel_hi:[1,0]
    v_pk_mul_f32 v[52:53], v[52:53], v[214:215] op_sel_hi:[1,0]
    v_pk_mul_f32 v[54:55], v[54:55], v[214:215] op_sel_hi:[1,0]
    v_pk_mul_f32 v[56:57], v[56:57], v[214:215] op_sel_hi:[1,0]
    v_pk_mul_f32 v[58:59], v[58:59], v[214:215] op_sel_hi:[1,0]
    v_pk_mul_f32 v[60:61], v[60:61], v[214:215] op_sel_hi:[1,0]
    v_pk_mul_f32 v[62:63], v[62:63], v[214:215] op_sel_hi:[1,0]
    v_pk_mul_f32 v[64:65], v[64:65], v[214:215] op_sel_hi:[1,0]
    v_pk_mul_f32 v[66:67], v[66:67], v[214:215] op_sel_hi:[1,0]
    v_pk_mul_f32 v[68:69], v[68:69], v[214:215] op_sel_hi:[1,0]
    v_pk_mul_f32 v[70:71], v[70:71], v[214:215] op_sel_hi:[1,0]
    v_pk_mul_f32 v[72:73], v[72:73], v[214:215] op_sel_hi:[1,0]
    v_pk_mul_f32 v[74:75], v[74:75], v[214:215] op_sel_hi:[1,0]
    v_pk_mul_f32 v[76:77], v[76:77], v[214:215] op_sel_hi:[1,0]
    v_pk_mul_f32 v[78:79], v[78:79], v[214:215] op_sel_hi:[1,0]
    v_pk_mul_f32 v[80:81], v[80:81], v[214:215] op_sel_hi:[1,0]
    v_pk_mul_f32 v[82:83], v[82:83], v[214:215] op_sel_hi:[1,0]
    v_pk_mul_f32 v[84:85], v[84:85], v[214:215] op_sel_hi:[1,0]
    v_pk_mul_f32 v[86:87], v[86:87], v[214:215] op_sel_hi:[1,0]
    v_pk_mul_f32 v[88:89], v[88:89], v[214:215] op_sel_hi:[1,0]
    v_pk_mul_f32 v[90:91], v[90:91], v[214:215] op_sel_hi:[1,0]
    v_pk_mul_f32 v[92:93], v[92:93], v[214:215] op_sel_hi:[1,0]
    v_pk_mul_f32 v[94:95], v[94:95], v[214:215] op_sel_hi:[1,0]
    v_pk_mul_f32 v[96:97], v[96:97], v[214:215] op_sel_hi:[1,0]
    v_pk_mul_f32 v[98:99], v[98:99], v[214:215] op_sel_hi:[1,0]
    s_mov_b32 s25, 0
attn_noresc_15:
    s_waitcnt vmcnt(0)
    s_barrier
    ds_read_b128 v[180:183], v229
    ds_read_b128 v[184:187], v229 offset:1024
    ds_read_b128 v[188:191], v229 offset:2048
    ds_read_b128 v[192:195], v229 offset:3072
    ds_read_b128 v[196:199], v229 offset:4096
    ds_read_b128 v[200:203], v229 offset:5120
    ds_read_b128 v[204:207], v229 offset:6144
    ds_read_b128 v[208:211], v229 offset:7168
    s_waitcnt lgkmcnt(7)
    v_mfma_f32_32x32x16_bf16 v[36:51], v[180:183], v[164:167], v[36:51]
    ds_read_b128 v[180:183], v229 offset:8192
    s_waitcnt lgkmcnt(7)
    v_mfma_f32_32x32x16_bf16 v[52:67], v[184:187], v[164:167], v[52:67]
    ds_read_b128 v[184:187], v229 offset:9216
    s_waitcnt lgkmcnt(7)
    v_mfma_f32_32x32x16_bf16 v[68:83], v[188:191], v[164:167], v[68:83]
    ds_read_b128 v[188:191], v229 offset:10240
    s_waitcnt lgkmcnt(7)
    v_mfma_f32_32x32x16_bf16 v[84:99], v[192:195], v[164:167], v[84:99]
    ds_read_b128 v[192:195], v229 offset:11264
    s_waitcnt lgkmcnt(7)
    v_mfma_f32_32x32x16_bf16 v[36:51], v[196:199], v[168:171], v[36:51]
    ds_read_b128 v[196:199], v229 offset:12288
    s_waitcnt lgkmcnt(7)
    v_mfma_f32_32x32x16_bf16 v[52:67], v[200:203], v[168:171], v[52:67]
    ds_read_b128 v[200:203], v229 offset:13312
    s_waitcnt lgkmcnt(7)
    v_mfma_f32_32x32x16_bf16 v[68:83], v[204:207], v[168:171], v[68:83]
    ds_read_b128 v[204:207], v229 offset:14336
    s_waitcnt lgkmcnt(7)
    v_mfma_f32_32x32x16_bf16 v[84:99], v[208:211], v[168:171], v[84:99]
    ds_read_b128 v[208:211], v229 offset:15360
    s_waitcnt lgkmcnt(7)
    v_mfma_f32_32x32x16_bf16 v[36:51], v[180:183], v[172:175], v[36:51]
    s_waitcnt lgkmcnt(6)
    v_mfma_f32_32x32x16_bf16 v[52:67], v[184:187], v[172:175], v[52:67]
    s_waitcnt lgkmcnt(5)
    v_mfma_f32_32x32x16_bf16 v[68:83], v[188:191], v[172:175], v[68:83]
    s_waitcnt lgkmcnt(4)
    v_mfma_f32_32x32x16_bf16 v[84:99], v[192:195], v[172:175], v[84:99]
    s_waitcnt lgkmcnt(3)
    v_mfma_f32_32x32x16_bf16 v[36:51], v[196:199], v[176:179], v[36:51]
    s_waitcnt lgkmcnt(2)
    v_mfma_f32_32x32x16_bf16 v[52:67], v[200:203], v[176:179], v[52:67]
    s_waitcnt lgkmcnt(1)
    v_mfma_f32_32x32x16_bf16 v[68:83], v[204:207], v[176:179], v[68:83]
    s_waitcnt lgkmcnt(0)
    v_mfma_f32_32x32x16_bf16 v[84:99], v[208:211], v[176:179], v[84:99]
    s_branch attn_merge
attn_single:
    s_waitcnt vmcnt(0)
    s_barrier
    s_cmp_lg_u32 s33, 0
    s_cselect_b32 s37, s31, s38
    s_cselect_b32 s11, 1, 0
    s_sub_u32 s33, s33, s11
    s_add_u32 s32, s37, 4096
    s_add_u32 s36, s34, 4096
    s_add_u32 s31, s31, 32768
    s_nop 1
    s_mov_b32 m0, s34
    s_nop 0
    buffer_load_dwordx4 v226, s[16:19], s37 offen lds
    s_mov_b32 m0, s34
    s_nop 0
    buffer_load_dwordx4 v226, s[16:19], s37 offen offset:1024 lds
    s_mov_b32 m0, s34
    s_nop 0
    buffer_load_dwordx4 v226, s[16:19], s37 offen offset:2048 lds
    s_mov_b32 m0, s34
    s_nop 0
    buffer_load_dwordx4 v226, s[16:19], s37 offen offset:3072 lds
    s_mov_b32 m0, s36
    s_nop 0
    buffer_load_dwordx4 v226, s[16:19], s32 offen lds
    s_mov_b32 m0, s36
    s_nop 0
    buffer_load_dwordx4 v226, s[16:19], s32 offen offset:1024 lds
    s_mov_b32 m0, s36
    s_nop 0
    buffer_load_dwordx4 v226, s[16:19], s32 offen offset:2048 lds
    s_mov_b32 m0, s36
    s_nop 0
    buffer_load_dwordx4 v226, s[16:19], s32 offen offset:3072 lds
    v_cmp_le_i32 s[44:45], 0, v225
    v_cmp_le_i32 s[46:47], 1, v225
    v_cmp_le_i32 s[48:49], 2, v225
    v_cmp_le_i32 s[50:51], 3, v225
    v_cndmask_b32 v100, v224, v100, s[44:45]
    v_cndmask_b32 v101, v224, v101, s[46:47]
    v_cndmask_b32 v102, v224, v102, s[48:49]
    v_cndmask_b32 v103, v224, v103, s[50:51]
    v_cmp_le_i32 s[44:45], 8, v225
    v_cmp_le_i32 s[46:47], 9, v225
    v_cmp_le_i32 s[48:49], 10, v225
    v_cmp_le_i32 s[50:51], 11, v225
    v_cndmask_b32 v104, v224, v104, s[44:45]
    v_cndmask_b32 v105, v224, v105, s[46:47]
    v_cndmask_b32 v106, v224, v106, s[48:49]
    v_cndmask_b32 v107, v224, v107, s[50:51]
    v_cmp_le_i32 s[44:45], 16, v225
    v_cmp_le_i32 s[46:47], 17, v225
    v_cmp_le_i32 s[48:49], 18, v225
    v_cmp_le_i32 s[50:51], 19, v225
    v_cndmask_b32 v108, v224, v108, s[44:45]
    v_cndmask_b32 v109, v224, v109, s[46:47]
    v_cndmask_b32 v110, v224, v110, s[48:49]
    v_cndmask_b32 v111, v224, v111, s[50:51]
    v_cmp_le_i32 s[44:45], 24, v225
    v_cmp_le_i32 s[46:47], 25, v225
    v_cmp_le_i32 s[48:49], 26, v225
    v_cmp_le_i32 s[50:51], 27, v225
    v_cndmask_b32 v112, v224, v112, s[44:45]
    v_cndmask_b32 v113, v224, v113, s[46:47]
    v_cndmask_b32 v114, v224, v114, s[48:49]
    v_cndmask_b32 v115, v224, v115, s[50:51]
    v_cmp_le_i32 s[44:45], 32, v225
    v_cmp_le_i32 s[46:47], 33, v225
    v_cmp_le_i32 s[48:49], 34, v225
    v_cmp_le_i32 s[50:51], 35, v225
    v_cndmask_b32 v116, v224, v116, s[44:45]
    v_cndmask_b32 v117, v224, v117, s[46:47]
    v_cndmask_b32 v118, v224, v118, s[48:49]
    v_cndmask_b32 v119, v224, v119, s[50:51]
    v_cmp_le_i32 s[44:45], 40, v225
    v_cmp_le_i32 s[46:47], 41, v225
    v_cmp_le_i32 s[48:49], 42, v225
    v_cmp_le_i32 s[50:51], 43, v225
    v_cndmask_b32 v120, v224, v120, s[44:45]
    v_cndmask_b32 v121, v224, v121, s[46:47]
    v_cndmask_b32 v122, v224, v122, s[48:49]
    v_cndmask_b32 v123, v224, v123, s[50:51]
    v_cmp_le_i32 s[44:45], 48, v225
    v_cmp_le_i32 s[46:47], 49, v225
    v_cmp_le_i32 s[48:49], 50, v225
    v_cmp_le_i32 s[50:51], 51, v225
    v_cndmask_b32 v124, v224, v124, s[44:45]
    v_cndmask_b32 v125, v224, v125, s[46:47]
    v_cndmask_b32 v126, v224, v126, s[48:49]
    v_cndmask_b32 v127, v224, v127, s[50:51]
    v_cmp_le_i32 s[44:45], 56, v225
    v_cmp_le_i32 s[46:47], 57, v225
    v_cmp_le_i32 s[48:49], 58, v225
    v_cmp_le_i32 s[50:51], 59, v225
    v_cndmask_b32 v128, v224, v128, s[44:45]
    v_cndmask_b32 v129, v224, v129, s[46:47]
    v_cndmask_b32 v130, v224, v130, s[48:49]
    v_cndmask_b32 v131, v224, v131, s[50:51]
    v_max3_f32 v220, v100, v101, v102
    v_max3_f32 v221, v108, v109, v110
    v_max3_f32 v222, v116, v117, v118
    v_max3_f32 v223, v124, v125, v126
    v_max3_f32 v220, v220, v103, v104
    v_max3_f32 v221, v221, v111, v112
    v_max3_f32 v222, v222, v119, v120
    v_max3_f32 v223, v223, v127, v128
    v_max3_f32 v220, v220, v105, v106
    v_max3_f32 v221, v221, v113, v114
    v_max3_f32 v222, v222, v121, v122
    v_max3_f32 v223, v223, v129, v130
    v_max_f32 v220, v220, v107
    v_max_f32 v221, v221, v115
    v_max_f32 v222, v222, v123
    v_max_f32 v223, v223, v131
    v_max3_f32 v220, v220, v221, v222
    v_max_f32 v220, v220, v223
    v_mov_b32 v221, v220
    s_nop 1
    v_permlane32_swap_b32 v220, v221
    v_max_f32 v220, v220, v221
    v_sub_f32 v221, v220, v212
    v_cmp_lt_f32 vcc, s24, v221
    s_cbranch_vccnz attn_rare_16
attn_back_17:
    v_fma_f32 v100, v100, s20, v216
    v_fma_f32 v101, v101, s20, v216
    v_fma_f32 v102, v102, s20, v216
    v_fma_f32 v103, v103, s20, v216
    v_exp_f32 v100, v100
    v_exp_f32 v101, v101
    v_exp_f32 v102, v102
    v_exp_f32 v103, v103
    v_fma_f32 v104, v104, s20, v216
    v_fma_f32 v105, v105, s20, v216
    v_fma_f32 v106, v106, s20, v216
    v_fma_f32 v107, v107, s20, v216
    v_exp_f32 v104, v104
    v_exp_f32 v105, v105
    v_exp_f32 v106, v106
    v_exp_f32 v107, v107
    v_fma_f32 v108, v108, s20, v216
    v_fma_f32 v109, v109, s20, v216
    v_fma_f32 v110, v110, s20, v216
    v_fma_f32 v111, v111, s20, v216
    v_exp_f32 v108, v108
    v_exp_f32 v109, v109
    v_exp_f32 v110, v110
    v_exp_f32 v111, v111
    v_fma_f32 v112, v112, s20, v216
    v_fma_f32 v113, v113, s20, v216
    v_fma_f32 v114, v114, s20, v216
    v_fma_f32 v115, v115, s20, v216
    v_exp_f32 v112, v112
    v_exp_f32 v113, v113
    v_exp_f32 v114, v114
    v_exp_f32 v115, v115
    v_fma_f32 v116, v116, s20, v216
    v_fma_f32 v117, v117, s20, v216
    v_fma_f32 v118, v118, s20, v216
    v_fma_f32 v119, v119, s20, v216
    v_exp_f32 v116, v116
    v_exp_f32 v117, v117
    v_exp_f32 v118, v118
    v_exp_f32 v119, v119
    v_fma_f32 v120, v120, s20, v216
    v_fma_f32 v121, v121, s20, v216
    v_fma_f32 v122, v122, s20, v216
    v_fma_f32 v123, v123, s20, v216
    v_exp_f32 v120, v120
    v_exp_f32 v121, v121
    v_exp_f32 v122, v122
    v_exp_f32 v123, v123
    v_fma_f32 v124, v124, s20, v216
    v_fma_f32 v125, v125, s20, v216
    v_fma_f32 v126, v126, s20, v216
    v_fma_f32 v127, v127, s20, v216
    v_exp_f32 v124, v124
    v_exp_f32 v125, v125
    v_exp_f32 v126, v126
    v_exp_f32 v127, v127
    v_fma_f32 v128, v128, s20, v216
    v_fma_f32 v129, v129, s20, v216
    v_fma_f32 v130, v130, s20, v216
    v_fma_f32 v131, v131, s20, v216
    v_exp_f32 v128, v128
    v_exp_f32 v129, v129
    v_exp_f32 v130, v130
    v_exp_f32 v131, v131
    v_add_f32 v220, v100, v101
    v_add_f32 v221, v108, v109
    v_add_f32 v222, v116, v117
    v_add_f32 v223, v124, v125
    v_add_f32 v220, v220, v102
    v_add_f32 v221, v221, v110
    v_add_f32 v222, v222, v118
    v_add_f32 v223, v223, v126
    v_add_f32 v220, v220, v103
    v_add_f32 v221, v221, v111
    v_add_f32 v222, v222, v119
    v_add_f32 v223, v223, v127
    v_add_f32 v220, v220, v104
    v_add_f32 v221, v221, v112
    v_add_f32 v222, v222, v120
    v_add_f32 v223, v223, v128
    v_add_f32 v220, v220, v105
    v_add_f32 v221, v221, v113
    v_add_f32 v222, v222, v121
    v_add_f32 v223, v223, v129
    v_add_f32 v220, v220, v106
    v_add_f32 v221, v221, v114
    v_add_f32 v222, v222, v122
    v_add_f32 v223, v223, v130
    v_add_f32 v220, v220, v107
    v_add_f32 v221, v221, v115
    v_add_f32 v222, v222, v123
    v_add_f32 v223, v223, v131
    v_add_f32 v220, v220, v221
    v_add_f32 v222, v222, v223
    v_add_f32 v220, v220, v222
    v_add_f32 v213, v213, v220
    v_cvt_pk_bf16_f32 v164, v100, v101
    v_cvt_pk_bf16_f32 v165, v102, v103
    v_cvt_pk_bf16_f32 v166, v104, v105
    v_cvt_pk_bf16_f32 v167, v106, v107
    v_cvt_pk_bf16_f32 v168, v108, v109
    v_cvt_pk_bf16_f32 v169, v110, v111
    v_cvt_pk_bf16_f32 v170, v112, v113
    v_cvt_pk_bf16_f32 v171, v114, v115
    v_cvt_pk_bf16_f32 v172, v116, v117
    v_cvt_pk_bf16_f32 v173, v118, v119
    v_cvt_pk_bf16_f32 v174, v120, v121
    v_cvt_pk_bf16_f32 v175, v122, v123
    v_cvt_pk_bf16_f32 v176, v124, v125
    v_cvt_pk_bf16_f32 v177, v126, v127
    v_cvt_pk_bf16_f32 v178, v128, v129
    v_cvt_pk_bf16_f32 v179, v130, v131
    s_cmp_eq_u32 s25, 0
    s_cbranch_scc1 attn_noresc_18
    v_pk_mul_f32 v[36:37], v[36:37], v[214:215] op_sel_hi:[1,0]
    v_pk_mul_f32 v[38:39], v[38:39], v[214:215] op_sel_hi:[1,0]
    v_pk_mul_f32 v[40:41], v[40:41], v[214:215] op_sel_hi:[1,0]
    v_pk_mul_f32 v[42:43], v[42:43], v[214:215] op_sel_hi:[1,0]
    v_pk_mul_f32 v[44:45], v[44:45], v[214:215] op_sel_hi:[1,0]
    v_pk_mul_f32 v[46:47], v[46:47], v[214:215] op_sel_hi:[1,0]
    v_pk_mul_f32 v[48:49], v[48:49], v[214:215] op_sel_hi:[1,0]
    v_pk_mul_f32 v[50:51], v[50:51], v[214:215] op_sel_hi:[1,0]
    v_pk_mul_f32 v[52:53], v[52:53], v[214:215] op_sel_hi:[1,0]
    v_pk_mul_f32 v[54:55], v[54:55], v[214:215] op_sel_hi:[1,0]
    v_pk_mul_f32 v[56:57], v[56:57], v[214:215] op_sel_hi:[1,0]
    v_pk_mul_f32 v[58:59], v[58:59], v[214:215] op_sel_hi:[1,0]
    v_pk_mul_f32 v[60:61], v[60:61], v[214:215] op_sel_hi:[1,0]
    v_pk_mul_f32 v[62:63], v[62:63], v[214:215] op_sel_hi:[1,0]
    v_pk_mul_f32 v[64:65], v[64:65], v[214:215] op_sel_hi:[1,0]
    v_pk_mul_f32 v[66:67], v[66:67], v[214:215] op_sel_hi:[1,0]
    v_pk_mul_f32 v[68:69], v[68:69], v[214:215] op_sel_hi:[1,0]
    v_pk_mul_f32 v[70:71], v[70:71], v[214:215] op_sel_hi:[1,0]
    v_pk_mul_f32 v[72:73], v[72:73], v[214:215] op_sel_hi:[1,0]
    v_pk_mul_f32 v[74:75], v[74:75], v[214:215] op_sel_hi:[1,0]
    v_pk_mul_f32 v[76:77], v[76:77], v[214:215] op_sel_hi:[1,0]
    v_pk_mul_f32 v[78:79], v[78:79], v[214:215] op_sel_hi:[1,0]
    v_pk_mul_f32 v[80:81], v[80:81], v[214:215] op_sel_hi:[1,0]
    v_pk_mul_f32 v[82:83], v[82:83], v[214:215] op_sel_hi:[1,0]
    v_pk_mul_f32 v[84:85], v[84:85], v[214:215] op_sel_hi:[1,0]
    v_pk_mul_f32 v[86:87], v[86:87], v[214:215] op_sel_hi:[1,0]
    v_pk_mul_f32 v[88:89], v[88:89], v[214:215] op_sel_hi:[1,0]
    v_pk_mul_f32 v[90:91], v[90:91], v[214:215] op_sel_hi:[1,0]
    v_pk_mul_f32 v[92:93], v[92:93], v[214:215] op_sel_hi:[1,0]
    v_pk_mul_f32 v[94:95], v[94:95], v[214:215] op_sel_hi:[1,0]
    v_pk_mul_f32 v[96:97], v[96:97], v[214:215] op_sel_hi:[1,0]
    v_pk_mul_f32 v[98:99], v[98:99], v[214:215] op_sel_hi:[1,0]
    s_mov_b32 s25, 0
attn_noresc_18:
    s_waitcnt vmcnt(0)
    s_barrier
    ds_read_b128 v[180:183], v229
    ds_read_b128 v[184:187], v229 offset:1024
    ds_read_b128 v[188:191], v229 offset:2048
    ds_read_b128 v[192:195], v229 offset:3072
    ds_read_b128 v[196:199], v229 offset:4096
    ds_read_b128 v[200:203], v229 offset:5120
    ds_read_b128 v[204:207], v229 offset:6144
    ds_read_b128 v[208:211], v229 offset:7168
    s_waitcnt lgkmcnt(7)
    v_mfma_f32_32x32x16_bf16 v[36:51], v[180:183], v[164:167], v[36:51]
    ds_read_b128 v[180:183], v229 offset:8192
    s_waitcnt lgkmcnt(7)
    v_mfma_f32_32x32x16_bf16 v[52:67], v[184:187], v[164:167], v[52:67]
    ds_read_b128 v[184:187], v229 offset:9216
    s_waitcnt lgkmcnt(7)
    v_mfma_f32_32x32x16_bf16 v[68:83], v[188:191], v[164:167], v[68:83]
    ds_read_b128 v[188:191], v229 offset:10240
    s_waitcnt lgkmcnt(7)
    v_mfma_f32_32x32x16_bf16 v[84:99], v[192:195], v[164:167], v[84:99]
    ds_read_b128 v[192:195], v229 offset:11264
    s_waitcnt lgkmcnt(7)
    v_mfma_f32_32x32x16_bf16 v[36:51], v[196:199], v[168:171], v[36:51]
    ds_read_b128 v[196:199], v229 offset:12288
    s_waitcnt lgkmcnt(7)
    v_mfma_f32_32x32x16_bf16 v[52:67], v[200:203], v[168:171], v[52:67]
    ds_read_b128 v[200:203], v229 offset:13312
    s_waitcnt lgkmcnt(7)
    v_mfma_f32_32x32x16_bf16 v[68:83], v[204:207], v[168:171], v[68:83]
    ds_read_b128 v[204:207], v229 offset:14336
    s_waitcnt lgkmcnt(7)
    v_mfma_f32_32x32x16_bf16 v[84:99], v[208:211], v[168:171], v[84:99]
    ds_read_b128 v[208:211], v229 offset:15360
    s_waitcnt lgkmcnt(7)
    v_mfma_f32_32x32x16_bf16 v[36:51], v[180:183], v[172:175], v[36:51]
    s_waitcnt lgkmcnt(6)
    v_mfma_f32_32x32x16_bf16 v[52:67], v[184:187], v[172:175], v[52:67]
    s_waitcnt lgkmcnt(5)
    v_mfma_f32_32x32x16_bf16 v[68:83], v[188:191], v[172:175], v[68:83]
    s_waitcnt lgkmcnt(4)
    v_mfma_f32_32x32x16_bf16 v[84:99], v[192:195], v[172:175], v[84:99]
    s_waitcnt lgkmcnt(3)
    v_mfma_f32_32x32x16_bf16 v[36:51], v[196:199], v[176:179], v[36:51]
    s_waitcnt lgkmcnt(2)
    v_mfma_f32_32x32x16_bf16 v[52:67], v[200:203], v[176:179], v[52:67]
    s_waitcnt lgkmcnt(1)
    v_mfma_f32_32x32x16_bf16 v[68:83], v[204:207], v[176:179], v[68:83]
    s_waitcnt lgkmcnt(0)
    v_mfma_f32_32x32x16_bf16 v[84:99], v[208:211], v[176:179], v[84:99]
attn_merge:
    s_cmp_eq_u32 s8, 0
    s_cbranch_scc1 attn_g0
    s_nop 3
    ds_write_b128 v231, v[36:39]
    ds_write_b128 v231, v[40:43] offset:1024
    ds_write_b128 v231, v[44:47] offset:2048
    ds_write_b128 v231, v[48:51] offset:3072
    ds_write_b128 v231, v[52:55] offset:4096
    ds_write_b128 v231, v[56:59] offset:5120
    ds_write_b128 v231, v[60:63] offset:6144
    ds_write_b128 v231, v[64:67] offset:7168
    ds_write_b128 v231, v[68:71] offset:8192
    ds_write_b128 v231, v[72:75] offset:9216
    ds_write_b128 v231, v[76:79] offset:10240
    ds_write_b128 v231, v[80:83] offset:11264
    ds_write_b128 v231, v[84:87] offset:12288
    ds_write_b128 v231, v[88:91] offset:13312
    ds_write_b128 v231, v[92:95] offset:14336
    ds_write_b128 v231, v[96:99] offset:15360
    s_lshl_b32 s11, s7, 9
    s_add_u32 s11, s11, 131072
    v_lshlrev_b32 v1, 3, v2
    v_add_u32 v1, s11, v1
    ds_write_b64 v1, v[212:213]
    s_waitcnt lgkmcnt(0)
    s_barrier
    s_barrier
    s_branch attn_next
attn_g0:
    s_barrier
    ds_read_b128 v[100:103], v231
    ds_read_b128 v[104:107], v231 offset:1024
    ds_read_b128 v[108:111], v231 offset:2048
    ds_read_b128 v[112:115], v231 offset:3072
    ds_read_b128 v[116:119], v231 offset:4096
    ds_read_b128 v[120:123], v231 offset:5120
    ds_read_b128 v[124:127], v231 offset:6144
    ds_read_b128 v[128:131], v231 offset:7168
    ds_read_b128 v[132:135], v231 offset:8192
    ds_read_b128 v[136:139], v231 offset:9216
    ds_read_b128 v[140:143], v231 offset:10240
    ds_read_b128 v[144:147], v231 offset:11264
    ds_read_b128 v[148:151], v231 offset:12288
    ds_read_b128 v[152:155], v231 offset:13312
    ds_read_b128 v[156:159], v231 offset:14336
    ds_read_b128 v[160:163], v231 offset:15360
    s_lshl_b32 s11, s7, 9
    s_add_u32 s11, s11, 131072
    v_lshlrev_b32 v1, 3, v2
    v_add_u32 v1, s11, v1
    ds_read_b64 v[220:221], v1
    s_waitcnt lgkmcnt(0)
    s_barrier
    v_max_f32 v218, v212, v220
    v_sub_f32 v214, v212, v218
    v_sub_f32 v216, v220, v218
    v_mul_f32 v214, s20, v214
    v_mul_f32 v216, s20, v216
    v_exp_f32 v214, v214
    v_exp_f32 v216, v216
    v_mul_f32 v213, v213, v214
    v_fmac_f32 v213, v221, v216
    v_mov_b32 v222, v213
    s_nop 1
    v_permlane32_swap_b32 v213, v222
    v_add_f32 v213, v213, v222
    v_rcp_f32 v213, v213
    s_nop 0
    v_mul_f32 v214, v214, v213
    v_mul_f32 v216, v216, v213
    v_mul_f32 v36, v36, v214
    v_fmac_f32 v36, v100, v216
    v_mul_f32 v37, v37, v214
    v_fmac_f32 v37, v101, v216
    v_mul_f32 v38, v38, v214
    v_fmac_f32 v38, v102, v216
    v_mul_f32 v39, v39, v214
    v_fmac_f32 v39, v103, v216
    v_mul_f32 v40, v40, v214
    v_fmac_f32 v40, v104, v216
    v_mul_f32 v41, v41, v214
    v_fmac_f32 v41, v105, v216
    v_mul_f32 v42, v42, v214
    v_fmac_f32 v42, v106, v216
    v_mul_f32 v43, v43, v214
    v_fmac_f32 v43, v107, v216
    v_cvt_pk_bf16_f32 v164, v36, v37
    v_cvt_pk_bf16_f32 v165, v38, v39
    v_cvt_pk_bf16_f32 v166, v40, v41
    v_cvt_pk_bf16_f32 v167, v42, v43
    buffer_store_dwordx4 v[164:167], v226, s[16:19], s41 offen
    v_mul_f32 v44, v44, v214
    v_fmac_f32 v44, v108, v216
    v_mul_f32 v45, v45, v214
    v_fmac_f32 v45, v109, v216
    v_mul_f32 v46, v46, v214
    v_fmac_f32 v46, v110, v216
    v_mul_f32 v47, v47, v214
    v_fmac_f32 v47, v111, v216
    v_mul_f32 v48, v48, v214
    v_fmac_f32 v48, v112, v216
    v_mul_f32 v49, v49, v214
    v_fmac_f32 v49, v113, v216
    v_mul_f32 v50, v50, v214
    v_fmac_f32 v50, v114, v216
    v_mul_f32 v51, v51, v214
    v_fmac_f32 v51, v115, v216
    v_cvt_pk_bf16_f32 v168, v44, v45
    v_cvt_pk_bf16_f32 v169, v46, v47
    v_cvt_pk_bf16_f32 v170, v48, v49
    v_cvt_pk_bf16_f32 v171, v50, v51
    buffer_store_dwordx4 v[168:171], v226, s[16:19], s41 offen offset:1024
    v_mul_f32 v52, v52, v214
    v_fmac_f32 v52, v116, v216
    v_mul_f32 v53, v53, v214
    v_fmac_f32 v53, v117, v216
    v_mul_f32 v54, v54, v214
    v_fmac_f32 v54, v118, v216
    v_mul_f32 v55, v55, v214
    v_fmac_f32 v55, v119, v216
    v_mul_f32 v56, v56, v214
    v_fmac_f32 v56, v120, v216
    v_mul_f32 v57, v57, v214
    v_fmac_f32 v57, v121, v216
    v_mul_f32 v58, v58, v214
    v_fmac_f32 v58, v122, v216
    v_mul_f32 v59, v59, v214
    v_fmac_f32 v59, v123, v216
    v_cvt_pk_bf16_f32 v172, v52, v53
    v_cvt_pk_bf16_f32 v173, v54, v55
    v_cvt_pk_bf16_f32 v174, v56, v57
    v_cvt_pk_bf16_f32 v175, v58, v59
    buffer_store_dwordx4 v[172:175], v226, s[16:19], s41 offen offset:2048
    v_mul_f32 v60, v60, v214
    v_fmac_f32 v60, v124, v216
    v_mul_f32 v61, v61, v214
    v_fmac_f32 v61, v125, v216
    v_mul_f32 v62, v62, v214
    v_fmac_f32 v62, v126, v216
    v_mul_f32 v63, v63, v214
    v_fmac_f32 v63, v127, v216
    v_mul_f32 v64, v64, v214
    v_fmac_f32 v64, v128, v216
    v_mul_f32 v65, v65, v214
    v_fmac_f32 v65, v129, v216
    v_mul_f32 v66, v66, v214
    v_fmac_f32 v66, v130, v216
    v_mul_f32 v67, v67, v214
    v_fmac_f32 v67, v131, v216
    v_cvt_pk_bf16_f32 v176, v60, v61
    v_cvt_pk_bf16_f32 v177, v62, v63
    v_cvt_pk_bf16_f32 v178, v64, v65
    v_cvt_pk_bf16_f32 v179, v66, v67
    buffer_store_dwordx4 v[176:179], v226, s[16:19], s41 offen offset:3072
    v_mul_f32 v68, v68, v214
    v_fmac_f32 v68, v132, v216
    v_mul_f32 v69, v69, v214
    v_fmac_f32 v69, v133, v216
    v_mul_f32 v70, v70, v214
    v_fmac_f32 v70, v134, v216
    v_mul_f32 v71, v71, v214
    v_fmac_f32 v71, v135, v216
    v_mul_f32 v72, v72, v214
    v_fmac_f32 v72, v136, v216
    v_mul_f32 v73, v73, v214
    v_fmac_f32 v73, v137, v216
    v_mul_f32 v74, v74, v214
    v_fmac_f32 v74, v138, v216
    v_mul_f32 v75, v75, v214
    v_fmac_f32 v75, v139, v216
    v_cvt_pk_bf16_f32 v164, v68, v69
    v_cvt_pk_bf16_f32 v165, v70, v71
    v_cvt_pk_bf16_f32 v166, v72, v73
    v_cvt_pk_bf16_f32 v167, v74, v75
    buffer_store_dwordx4 v[164:167], v226, s[16:19], s42 offen
    v_mul_f32 v76, v76, v214
    v_fmac_f32 v76, v140, v216
    v_mul_f32 v77, v77, v214
    v_fmac_f32 v77, v141, v216
    v_mul_f32 v78, v78, v214
    v_fmac_f32 v78, v142, v216
    v_mul_f32 v79, v79, v214
    v_fmac_f32 v79, v143, v216
    v_mul_f32 v80, v80, v214
    v_fmac_f32 v80, v144, v216
    v_mul_f32 v81, v81, v214
    v_fmac_f32 v81, v145, v216
    v_mul_f32 v82, v82, v214
    v_fmac_f32 v82, v146, v216
    v_mul_f32 v83, v83, v214
    v_fmac_f32 v83, v147, v216
    v_cvt_pk_bf16_f32 v168, v76, v77
    v_cvt_pk_bf16_f32 v169, v78, v79
    v_cvt_pk_bf16_f32 v170, v80, v81
    v_cvt_pk_bf16_f32 v171, v82, v83
    buffer_store_dwordx4 v[168:171], v226, s[16:19], s42 offen offset:1024
    v_mul_f32 v84, v84, v214
    v_fmac_f32 v84, v148, v216
    v_mul_f32 v85, v85, v214
    v_fmac_f32 v85, v149, v216
    v_mul_f32 v86, v86, v214
    v_fmac_f32 v86, v150, v216
    v_mul_f32 v87, v87, v214
    v_fmac_f32 v87, v151, v216
    v_mul_f32 v88, v88, v214
    v_fmac_f32 v88, v152, v216
    v_mul_f32 v89, v89, v214
    v_fmac_f32 v89, v153, v216
    v_mul_f32 v90, v90, v214
    v_fmac_f32 v90, v154, v216
    v_mul_f32 v91, v91, v214
    v_fmac_f32 v91, v155, v216
    v_cvt_pk_bf16_f32 v172, v84, v85
    v_cvt_pk_bf16_f32 v173, v86, v87
    v_cvt_pk_bf16_f32 v174, v88, v89
    v_cvt_pk_bf16_f32 v175, v90, v91
    buffer_store_dwordx4 v[172:175], v226, s[16:19], s42 offen offset:2048
    v_mul_f32 v92, v92, v214
    v_fmac_f32 v92, v156, v216
    v_mul_f32 v93, v93, v214
    v_fmac_f32 v93, v157, v216
    v_mul_f32 v94, v94, v214
    v_fmac_f32 v94, v158, v216
    v_mul_f32 v95, v95, v214
    v_fmac_f32 v95, v159, v216
    v_mul_f32 v96, v96, v214
    v_fmac_f32 v96, v160, v216
    v_mul_f32 v97, v97, v214
    v_fmac_f32 v97, v161, v216
    v_mul_f32 v98, v98, v214
    v_fmac_f32 v98, v162, v216
    v_mul_f32 v99, v99, v214
    v_fmac_f32 v99, v163, v216
    v_cvt_pk_bf16_f32 v176, v92, v93
    v_cvt_pk_bf16_f32 v177, v94, v95
    v_cvt_pk_bf16_f32 v178, v96, v97
    v_cvt_pk_bf16_f32 v179, v98, v99
    buffer_store_dwordx4 v[176:179], v226, s[16:19], s42 offen offset:3072
attn_next:
    s_add_u32 s26, s26, 1
    s_cmp_lt_u32 s26, 2
    s_cbranch_scc1 attn_blk
attn_end:
    s_endpgm
attn_rare_1:
    v_max3_f32 v218, v212, v220, s23
    v_sub_f32 v214, v212, v218
    v_mul_f32 v216, s22, v218
    v_mul_f32 v214, s20, v214
    v_mov_b32 v212, v218
    v_exp_f32 v214, v214
    s_nop 0
    v_mul_f32 v213, v213, v214
    s_mov_b32 s25, 1
    s_branch attn_back_2
attn_rare_4:
    v_max3_f32 v218, v212, v220, s23
    v_sub_f32 v214, v212, v218
    v_mul_f32 v216, s22, v218
    v_mul_f32 v214, s20, v214
    v_mov_b32 v212, v218
    v_exp_f32 v214, v214
    s_nop 0
    v_mul_f32 v213, v213, v214
    s_mov_b32 s25, 1
    s_branch attn_back_5
attn_rare_7:
    v_max3_f32 v218, v212, v220, s23
    v_sub_f32 v214, v212, v218
    v_mul_f32 v216, s22, v218
    v_mul_f32 v214, s20, v214
    v_mov_b32 v212, v218
    v_exp_f32 v214, v214
    s_nop 0
    v_mul_f32 v213, v213, v214
    s_mov_b32 s25, 1
    s_branch attn_back_8
attn_rare_10:
    v_max3_f32 v218, v212, v220, s23
    v_sub_f32 v214, v212, v218
    v_mul_f32 v216, s22, v218
    v_mul_f32 v214, s20, v214
    v_mov_b32 v212, v218
    v_exp_f32 v214, v214
    s_nop 0
    v_mul_f32 v213, v213, v214
    s_mov_b32 s25, 1
    s_branch attn_back_11
attn_rare_13:
    v_max3_f32 v218, v212, v220, s23
    v_sub_f32 v214, v212, v218
    v_mul_f32 v216, s22, v218
    v_mul_f32 v214, s20, v214
    v_mov_b32 v212, v218
    v_exp_f32 v214, v214
    s_nop 0
    v_mul_f32 v213, v213, v214
    s_mov_b32 s25, 1
    s_branch attn_back_14
attn_rare_16:
    v_max3_f32 v218, v212, v220, s23
    v_sub_f32 v214, v212, v218
    v_mul_f32 v216, s22, v218
    v_mul_f32 v214, s20, v214
    v_mov_b32 v212, v218
    v_exp_f32 v214, v214
    s_nop 0
    v_mul_f32 v213, v213, v214
    s_mov_b32 s25, 1
    s_branch attn_back_17
.section .rodata,"a"
.p2align 6
.amdhsa_kernel attn_kernel
  .amdhsa_next_free_vgpr 240
  .amdhsa_next_free_sgpr 55
  .amdhsa_accum_offset 240
  .amdhsa_group_segment_fixed_size 0
  .amdhsa_kernarg_size 112
  .amdhsa_user_sgpr_count 2
  .amdhsa_user_sgpr_kernarg_segment_ptr 1
  .amdhsa_system_sgpr_workgroup_id_x 1
.end_amdhsa_kernel

.text
.globl outg_kernel
.p2align 8
.type outg_kernel,@function
outg_kernel:
    s_cmp_ge_u32 s2, 256
    s_cbranch_scc1 outg_end
    s_load_dwordx2 s[4:5], s[0:1], 40
    s_load_dwordx2 s[6:7], s[0:1], 72
    s_load_dwordx2 s[8:9], s[0:1], 104
    v_lshrrev_b32 v1, 6, v0
    v_and_b32 v2, 63, v0
    v_readfirstlane_b32 s10, v1
    v_lshrrev_b32 v3, 5, v2
    s_and_b32 s11, s10, 3
    s_lshr_b32 s12, s10, 2
    s_lshr_b32 s16, s2, 3
    s_and_b32 s14, s16, 3
    s_bfe_u32 s15, s16, 0x20002
    s_lshr_b32 s16, s16, 4
    s_lshl_b32 s16, s16, 3
    s_and_b32 s13, s2, 7
    s_add_u32 s13, s13, s16
    s_waitcnt lgkmcnt(0)
    s_cmp_eq_u32 s15, 3
    s_cselect_b32 s20, s6, s4
    s_cselect_b32 s21, s7, s5
    s_mov_b32 s16, 0x158000
    s_cselect_b32 s22, s16, 0x400000
    s_mov_b32 s23, 0x20000
    s_mov_b32 s24, s8
    s_mov_b32 s25, s9
    s_mov_b32 s26, 0x10000000
    s_mov_b32 s27, 0x20000
    s_mov_b32 s28, 0
    s_cmp_eq_u32 s15, 1
    s_cselect_b32 s28, 86, s28
    s_cmp_eq_u32 s15, 2
    s_cselect_b32 s28, 171, s28
    s_mov_b32 s29, 86
    s_cmp_eq_u32 s15, 1
    s_cselect_b32 s29, 85, s29
    s_cmp_eq_u32 s15, 2
    s_cselect_b32 s29, 85, s29
    s_mov_b32 s36, 0x40000000
    s_cmp_ge_u32 s10, 4
    s_cbranch_scc1 outg_wrole
    v_lshlrev_b32 v4, 4, v2
    s_lshl_b32 s16, s13, 2
    s_add_u32 s16, s16, s10
    s_lshl_b32 s30, s16, 18
    s_add_u32 s30, s30, 0x3000000
    s_mul_i32 s17, s16, 88064
    s_add_u32 s17, s17, 0x4000000
    s_cmp_eq_u32 s15, 3
    s_cselect_b32 s30, s17, s30
    s_lshl_b32 s16, s28, 10
    s_add_u32 s30, s30, s16
    s_lshl_b32 s33, s10, 12
    s_mov_b32 s37, 4096
    s_branch outg_roledone
outg_wrole:
    v_lshrrev_b32 v4, 2, v2
    v_lshlrev_b32 v4, 10, v4
    v_and_b32 v5, 3, v2
    v_lshlrev_b32 v5, 4, v5
    v_add_u32 v4, v4, v5
    s_sub_u32 s16, s10, 4
    s_lshl_b32 s30, s14, 7
    s_lshl_b32 s17, s16, 5
    s_add_u32 s30, s30, s17
    s_lshl_b32 s30, s30, 1
    s_lshl_b32 s17, s28, 14
    s_add_u32 s30, s30, s17
    s_lshl_b32 s33, s16, 12
    s_add_u32 s33, s33, 16384
    s_mov_b32 s37, 65536
outg_roledone:
    s_mov_b32 s34, s29
    s_mov_b32 s35, 0
    s_cmp_ge_u32 s10, 4
    s_cselect_b32 s44, s20, s24
    s_cselect_b32 s45, s21, s25
    s_cselect_b32 s46, s22, s26
    s_mov_b32 s47, 0x20000
    v_and_b32 v5, 15, v2
    v_lshrrev_b32 v5, 2, v5
    v_lshlrev_b32 v6, 2, v3
    v_add_u32 v5, v5, v6
    v_lshlrev_b32 v7, 6, v5
    v_lshrrev_b32 v5, 4, v2
    v_and_b32 v5, 1, v5
    v_lshlrev_b32 v5, 5, v5
    v_add_u32 v7, v7, v5
    v_and_b32 v5, 3, v2
    v_lshlrev_b32 v5, 3, v5
    v_add_u32 v7, v7, v5
    s_lshl_b32 s16, s12, 13
    s_add_u32 s16, s16, 16384
    v_add_u32 v7, s16, v7
    v_lshlrev_b32 v8, 4, v2
    s_lshl_b32 s16, s11, 12
    v_add_u32 v8, s16, v8
    s_add_u32 s32, s35, s33
    s_mov_b32 m0, s32
    s_add_u32 s39, s30, 15360
    s_add_u32 s40, s30, 30720
    s_add_u32 s41, s30, 46080
    s_cmp_ge_u32 s10, 4
    s_cselect_b32 s39, s39, s30
    s_cselect_b32 s40, s40, s30
    s_cselect_b32 s41, s41, s30
    s_cmp_gt_i32 s34, 0
    s_cselect_b32 s31, s30, s36
    buffer_load_dwordx4 v4, s[44:47], s31 offen lds
    s_cmp_gt_i32 s34, 1
    s_cselect_b32 s31, s39, s36
    buffer_load_dwordx4 v4, s[44:47], s31 offen offset:1024 lds
    s_cmp_gt_i32 s34, 2
    s_cselect_b32 s31, s40, s36
    buffer_load_dwordx4 v4, s[44:47], s31 offen offset:2048 lds
    s_cmp_gt_i32 s34, 3
    s_cselect_b32 s31, s41, s36
    buffer_load_dwordx4 v4, s[44:47], s31 offen offset:3072 lds
    s_add_u32 s30, s30, s37
    s_sub_u32 s34, s34, 4
    s_add_u32 s35, s35, 32768
    s_and_b32 s35, s35, 131071
    s_add_u32 s32, s35, s33
    s_mov_b32 m0, s32
    s_add_u32 s39, s30, 15360
    s_add_u32 s40, s30, 30720
    s_add_u32 s41, s30, 46080
    s_cmp_ge_u32 s10, 4
    s_cselect_b32 s39, s39, s30
    s_cselect_b32 s40, s40, s30
    s_cselect_b32 s41, s41, s30
    s_cmp_gt_i32 s34, 0
    s_cselect_b32 s31, s30, s36
    buffer_load_dwordx4 v4, s[44:47], s31 offen lds
    s_cmp_gt_i32 s34, 1
    s_cselect_b32 s31, s39, s36
    buffer_load_dwordx4 v4, s[44:47], s31 offen offset:1024 lds
    s_cmp_gt_i32 s34, 2
    s_cselect_b32 s31, s40, s36
    buffer_load_dwordx4 v4, s[44:47], s31 offen offset:2048 lds
    s_cmp_gt_i32 s34, 3
    s_cselect_b32 s31, s41, s36
    buffer_load_dwordx4 v4, s[44:47], s31 offen offset:3072 lds
    s_add_u32 s30, s30, s37
    s_sub_u32 s34, s34, 4
    s_add_u32 s35, s35, 32768
    s_and_b32 s35, s35, 131071
    s_add_u32 s32, s35, s33
    s_mov_b32 m0, s32
    s_add_u32 s39, s30, 15360
    s_add_u32 s40, s30, 30720
    s_add_u32 s41, s30, 46080
    s_cmp_ge_u32 s10, 4
    s_cselect_b32 s39, s39, s30
    s_cselect_b32 s40, s40, s30
    s_cselect_b32 s41, s41, s30
    s_cmp_gt_i32 s34, 0
    s_cselect_b32 s31, s30, s36
    buffer_load_dwordx4 v4, s[44:47], s31 offen lds
    s_cmp_gt_i32 s34, 1
    s_cselect_b32 s31, s39, s36
    buffer_load_dwordx4 v4, s[44:47], s31 offen offset:1024 lds
    s_cmp_gt_i32 s34, 2
    s_cselect_b32 s31, s40, s36
    buffer_load_dwordx4 v4, s[44:47], s31 offen offset:2048 lds
    s_cmp_gt_i32 s34, 3
    s_cselect_b32 s31, s41, s36
    buffer_load_dwordx4 v4, s[44:47], s31 offen offset:3072 lds
    s_add_u32 s30, s30, s37
    s_sub_u32 s34, s34, 4
    s_add_u32 s35, s35, 32768
    s_and_b32 s35, s35, 131071
    s_mov_b32 s48, 0
    s_mov_b32 s49, 0
    v_mov_b32 v12, 0
    v_mov_b32 v13, 0
    v_mov_b32 v14, 0
    v_mov_b32 v15, 0
    v_mov_b32 v16, 0
    v_mov_b32 v17, 0
    v_mov_b32 v18, 0
    v_mov_b32 v19, 0
    v_mov_b32 v20, 0
    v_mov_b32 v21, 0
    v_mov_b32 v22, 0
    v_mov_b32 v23, 0
    v_mov_b32 v24, 0
    v_mov_b32 v25, 0
    v_mov_b32 v26, 0
    v_mov_b32 v27, 0
    v_mov_b32 v28, 0
    v_mov_b32 v29, 0
    v_mov_b32 v30, 0
    v_mov_b32 v31, 0
    v_mov_b32 v32, 0
    v_mov_b32 v33, 0
    v_mov_b32 v34, 0
    v_mov_b32 v35, 0
    v_mov_b32 v36, 0
    v_mov_b32 v37, 0
    v_mov_b32 v38, 0
    v_mov_b32 v39, 0
    v_mov_b32 v40, 0
    v_mov_b32 v41, 0
    v_mov_b32 v42, 0
    v_mov_b32 v43, 0
outg_loop:
    s_waitcnt vmcnt(8)
    s_barrier
    v_add_u32 v9, s48, v7
    v_add_u32 v10, s48, v8
    ds_read_b64_tr_b16 v[44:45], v9
    ds_read_b64_tr_b16 v[46:47], v9 offset:512
    ds_read_b64_tr_b16 v[48:49], v9 offset:4096
    ds_read_b64_tr_b16 v[50:51], v9 offset:4608
    ds_read_b128 v[68:71], v10
    ds_read_b64_tr_b16 v[52:53], v9 offset:1024
    ds_read_b64_tr_b16 v[54:55], v9 offset:1536
    ds_read_b64_tr_b16 v[56:57], v9 offset:5120
    ds_read_b64_tr_b16 v[58:59], v9 offset:5632
    ds_read_b128 v[72:75], v10 offset:1024
    s_add_u32 s32, s35, s33
    s_mov_b32 m0, s32
    s_add_u32 s39, s30, 15360
    s_add_u32 s40, s30, 30720
    s_add_u32 s41, s30, 46080
    s_cmp_ge_u32 s10, 4
    s_cselect_b32 s39, s39, s30
    s_cselect_b32 s40, s40, s30
    s_cselect_b32 s41, s41, s30
    s_cmp_gt_i32 s34, 0
    s_cselect_b32 s31, s30, s36
    buffer_load_dwordx4 v4, s[44:47], s31 offen lds
    s_cmp_gt_i32 s34, 1
    s_cselect_b32 s31, s39, s36
    buffer_load_dwordx4 v4, s[44:47], s31 offen offset:1024 lds
    s_cmp_gt_i32 s34, 2
    s_cselect_b32 s31, s40, s36
    buffer_load_dwordx4 v4, s[44:47], s31 offen offset:2048 lds
    s_cmp_gt_i32 s34, 3
    s_cselect_b32 s31, s41, s36
    buffer_load_dwordx4 v4, s[44:47], s31 offen offset:3072 lds
    s_add_u32 s30, s30, s37
    s_sub_u32 s34, s34, 4
    s_add_u32 s35, s35, 32768
    s_and_b32 s35, s35, 131071
    ds_read_b64_tr_b16 v[60:61], v9 offset:2048
    ds_read_b64_tr_b16 v[62:63], v9 offset:2560
    ds_read_b64_tr_b16 v[64:65], v9 offset:6144
    ds_read_b64_tr_b16 v[66:67], v9 offset:6656
    ds_read_b128 v[76:79], v10 offset:2048
    s_waitcnt lgkmcnt(10)
    v_mfma_f32_32x32x16_bf16 v[12:27], v[44:47], v[68:71], v[12:27]
    v_mfma_f32_32x32x16_bf16 v[28:43], v[48:51], v[68:71], v[28:43]
    ds_read_b64_tr_b16 v[44:45], v9 offset:3072
    ds_read_b64_tr_b16 v[46:47], v9 offset:3584
    ds_read_b64_tr_b16 v[48:49], v9 offset:7168
    ds_read_b64_tr_b16 v[50:51], v9 offset:7680
    ds_read_b128 v[68:71], v10 offset:3072
    s_waitcnt lgkmcnt(10)
    v_mfma_f32_32x32x16_bf16 v[12:27], v[52:55], v[72:75], v[12:27]
    v_mfma_f32_32x32x16_bf16 v[28:43], v[56:59], v[72:75], v[28:43]
    s_waitcnt lgkmcnt(5)
    v_mfma_f32_32x32x16_bf16 v[12:27], v[60:63], v[76:79], v[12:27]
    v_mfma_f32_32x32x16_bf16 v[28:43], v[64:67], v[76:79], v[28:43]
    s_waitcnt lgkmcnt(0)
    v_mfma_f32_32x32x16_bf16 v[12:27], v[44:47], v[68:71], v[12:27]
    v_mfma_f32_32x32x16_bf16 v[28:43], v[48:51], v[68:71], v[28:43]
    s_add_u32 s48, s48, 32768
    s_and_b32 s48, s48, 131071
    s_add_u32 s49, s49, 1
    s_cmp_lt_u32 s49, 22
    s_cbranch_scc1 outg_loop
    s_nop 15
    s_lshl_b32 s50, s13, 2
    s_add_u32 s50, s50, s14
    s_lshl_b32 s16, s15, 6
    s_add_u32 s50, s50, s16
    s_lshl_b32 s50, s50, 3
    s_add_u32 s50, s50, s10
    s_lshl_b32 s50, s50, 13
    s_add_u32 s50, s50, 0x5000000
    s_add_u32 s51, s50, 4096
    v_lshlrev_b32 v5, 4, v2
    buffer_store_dwordx4 v[12:15], v5, s[24:27], s50 offen
    buffer_store_dwordx4 v[16:19], v5, s[24:27], s50 offen offset:1024
    buffer_store_dwordx4 v[20:23], v5, s[24:27], s50 offen offset:2048
    buffer_store_dwordx4 v[24:27], v5, s[24:27], s50 offen offset:3072
    buffer_store_dwordx4 v[28:31], v5, s[24:27], s51 offen
    buffer_store_dwordx4 v[32:35], v5, s[24:27], s51 offen offset:1024
    buffer_store_dwordx4 v[36:39], v5, s[24:27], s51 offen offset:2048
    buffer_store_dwordx4 v[40:43], v5, s[24:27], s51 offen offset:3072
outg_end:
    s_endpgm
.section .rodata,"a"
.p2align 6
.amdhsa_kernel outg_kernel
  .amdhsa_next_free_vgpr 80
  .amdhsa_next_free_sgpr 52
  .amdhsa_accum_offset 80
  .amdhsa_group_segment_fixed_size 0
  .amdhsa_kernarg_size 112
  .amdhsa_user_sgpr_count 2
  .amdhsa_user_sgpr_kernarg_segment_ptr 1
  .amdhsa_system_sgpr_workgroup_id_x 1
.end_amdhsa_kernel

.text
.globl red_kernel
.p2align 8
.type red_kernel,@function
red_kernel:
    s_cmp_ge_u32 s2, 1024
    s_cbranch_scc1 red_end
    s_load_dwordx2 s[4:5], s[0:1], 0
    s_load_dwordx2 s[6:7], s[0:1], 80
    s_load_dwordx2 s[8:9], s[0:1], 88
    s_load_dwordx2 s[10:11], s[0:1], 104
    v_lshrrev_b32 v1, 6, v0
    v_and_b32 v2, 63, v0
    v_readfirstlane_b32 s12, v1
    v_lshrrev_b32 v3, 5, v2
    v_and_b32 v4, 31, v2
    s_lshl_b32 s13, s2, 2
    s_add_u32 s13, s13, s12
    s_and_b32 s18, s13, 7
    s_bfe_u32 s17, s13, 0x30003
    s_lshr_b32 s16, s13, 6
    s_waitcnt lgkmcnt(0)
    s_mov_b32 s20, s4
    s_mov_b32 s21, s5
    s_mov_b32 s22, 0x200000
    s_mov_b32 s23, 0x20000
    s_mov_b32 s24, s6
    s_mov_b32 s25, s7
    s_mov_b32 s26, 0x400
    s_mov_b32 s27, 0x20000
    s_mov_b32 s28, s8
    s_mov_b32 s29, s9
    s_mov_b32 s30, 0x200000
    s_mov_b32 s31, 0x20000
    s_mov_b32 s32, s10
    s_mov_b32 s33, s11
    s_mov_b32 s34, 0x10000000
    s_mov_b32 s35, 0x20000
    s_lshl_b32 s36, s13, 10
    s_add_u32 s36, s36, 0x5000000
    s_add_u32 s37, s36, 4194304
    s_add_u32 s38, s37, 4194304
    s_add_u32 s39, s38, 4194304
    v_lshlrev_b32 v5, 4, v2
    buffer_load_dwordx4 v[8:11], v5, s[32:35], s36 offen
    buffer_load_dwordx4 v[12:15], v5, s[32:35], s37 offen
    buffer_load_dwordx4 v[16:19], v5, s[32:35], s38 offen
    buffer_load_dwordx4 v[20:23], v5, s[32:35], s39 offen
    s_lshr_b32 s14, s16, 2
    s_lshl_b32 s14, s14, 7
    s_and_b32 s15, s17, 3
    s_lshl_b32 s15, s15, 5
    s_add_u32 s40, s14, s15
    s_lshl_b32 s40, s40, 10
    s_and_b32 s41, s16, 3
    s_lshl_b32 s41, s41, 7
    s_lshr_b32 s14, s17, 2
    s_lshl_b32 s14, s14, 6
    s_add_u32 s41, s41, s14
    s_lshl_b32 s14, s18, 3
    s_add_u32 s41, s41, s14
    s_lshl_b32 s41, s41, 1
    s_add_u32 s40, s40, s41
    v_lshlrev_b32 v24, 10, v4
    v_lshlrev_b32 v1, 3, v3
    v_add_u32 v24, v24, v1
    v_mov_b32 v25, v1
    buffer_load_dwordx2 v[26:27], v24, s[20:23], s40 offen
    buffer_load_dwordx2 v[28:29], v25, s[24:27], s41 offen
    s_waitcnt vmcnt(4)
    v_add_f32 v8, v8, v12
    v_add_f32 v9, v9, v13
    v_add_f32 v10, v10, v14
    v_add_f32 v11, v11, v15
    s_waitcnt vmcnt(3)
    v_add_f32 v8, v8, v16
    v_add_f32 v9, v9, v17
    v_add_f32 v10, v10, v18
    v_add_f32 v11, v11, v19
    s_waitcnt vmcnt(2)
    v_add_f32 v8, v8, v20
    v_add_f32 v9, v9, v21
    v_add_f32 v10, v10, v22
    v_add_f32 v11, v11, v23
    s_waitcnt vmcnt(0)
    v_lshlrev_b32 v32, 16, v26
    v_and_b32 v33, 0xffff0000, v26
    v_lshlrev_b32 v34, 16, v28
    v_and_b32 v35, 0xffff0000, v28
    v_add_f32 v32, v32, v34
    v_add_f32 v33, v33, v35
    v_add_f32 v8, v8, v32
    v_add_f32 v9, v9, v33
    v_lshlrev_b32 v32, 16, v27
    v_and_b32 v33, 0xffff0000, v27
    v_lshlrev_b32 v34, 16, v29
    v_and_b32 v35, 0xffff0000, v29
    v_add_f32 v32, v32, v34
    v_add_f32 v33, v33, v35
    v_add_f32 v10, v10, v32
    v_add_f32 v11, v11, v33
    v_cvt_pk_bf16_f32 v36, v8, v9
    v_cvt_pk_bf16_f32 v37, v10, v11
    buffer_store_dwordx2 v[36:37], v24, s[28:31], s40 offen
red_end:
    s_endpgm
.section .rodata,"a"
.p2align 6
.amdhsa_kernel red_kernel
  .amdhsa_next_free_vgpr 40
  .amdhsa_next_free_sgpr 42
  .amdhsa_accum_offset 40
  .amdhsa_group_segment_fixed_size 0
  .amdhsa_kernarg_size 112
  .amdhsa_user_sgpr_count 2
  .amdhsa_user_sgpr_kernarg_segment_ptr 1
  .amdhsa_system_sgpr_workgroup_id_x 1
.end_amdhsa_kernel
```
